```python
import torch

def _softmax(x, axis=-1):
    return torch.softmax(x, dim=axis)
def _gelu(x):
    return torch.nn.functional.gelu(x, approximate="tanh")
def _silu(x):
    return torch.nn.functional.silu(x)
def _sigmoid(x):
    return torch.sigmoid(x)
def _layernorm(x, axis=-1, eps=1e-5):
    m = x.mean(dim=axis, keepdim=True)
    v = x.var(dim=axis, keepdim=True, unbiased=False)
    return (x - m) / torch.sqrt(v + eps)
def _scatter_add(tgt, idx, src, axis=0):
    return tgt.clone().index_add_(axis, idx, src)
def _segment_sum(src, seg, n):
    out = torch.zeros((n,) + src.shape[1:], dtype=src.dtype)
    return out.index_add_(0, seg, src)
def _pad(x, pw):
    flat = tuple(v for pair in reversed(pw) for v in pair)
    return torch.nn.functional.pad(x, flat)

kernel_name = 'gated_mix__mha_block__softmax_full_mha__prompt'

def setup_inputs():

    _w = (lambda a: (lambda t: t.to(torch.bfloat16) if t.is_floating_point() else t)(torch.as_tensor(a)))
    def _A_setup():
        B, S, D, H = 1, 2048, 448, 16
        return {
            "x": _w((lambda *s: torch.randn(*s, dtype=torch.bfloat16) * 0.05)(B, S, D)),
            "wqkv": _w((lambda *s: torch.randn(*s, dtype=torch.bfloat16) * 0.8)(D, 3 * D)),
            "wo": _w((lambda *s: torch.randn(*s, dtype=torch.bfloat16) * 0.05)(D, D)),
        }
    _A_in = _A_setup()

    def _B_setup():
        B, S, D = 1, 2048, 448
        return {
            "x": _w((lambda *s: torch.randn(*s, dtype=torch.bfloat16) * 0.05)(B, S, D)),
            "wqkv": _w((lambda *s: torch.randn(*s, dtype=torch.bfloat16) * 0.8)(D, 3 * D)),
            "wo": _w((lambda *s: torch.randn(*s, dtype=torch.bfloat16) * 0.05)(D, D)),
        }
    _B_in = _B_setup()

    return {
        "A_x": _A_in["x"],
        "A_wqkv": _A_in["wqkv"],
        "A_wo": _A_in["wo"],
        "B_x": _B_in["x"],
        "B_wqkv": _B_in["wqkv"],
        "B_wo": _B_in["wo"],
        "gate_w": _w((lambda *s: torch.randn(*s, dtype=torch.bfloat16) * 0.05)(448) * 16.0),
    }

def reference(A_x, A_wqkv, A_wo, B_x, B_wqkv, B_wo, gate_w):
    def _A_ref(x, wqkv, wo):
        B, S, D = x.shape
        H = 16
        Dh = D // H
        qkv = (lambda x, *d: x.permute(*d))((x @ wqkv).reshape(B, S, 3, H, Dh), 2, 0, 3, 1, 4)
        q, k, v = qkv[0], qkv[1], qkv[2]
        scores = torch.einsum("bhqd,bhkd->bhqk", q, k) * (Dh ** -0.5)
        p = _softmax(scores, axis=-1)
        o = torch.einsum("bhqk,bhkd->bhqd", p, v)
        return (lambda x, *d: x.permute(*d))(o, 0, 2, 1, 3).reshape(B, S, D) @ wo

    def _B_ref(x, wqkv, wo):
        B, S, D = x.shape
        H = 16; Dh = D // H
        qkv = (lambda x, *d: x.permute(*d))((x @ wqkv).reshape(B, S, 3, H, Dh), 2, 0, 3, 1, 4)
        q, k, v = qkv[0], qkv[1], qkv[2]
        scale = Dh ** -0.5
        scores = torch.einsum("bhqd,bhkd->bhqk", q, k) * scale
        p = _softmax(scores, axis=-1)
        o = torch.einsum("bhqk,bhkd->bhqd", p, v)
        return (lambda x, *d: x.permute(*d))(o, 0, 2, 1, 3).reshape(B, S, D) @ wo

    x = A_x
    g = _sigmoid((x * gate_w).sum(-1, keepdims=True))
    a = _A_ref(x, A_wqkv, A_wo)
    b = _B_ref(x, B_wqkv, B_wo)
    return g * a + (1 - g) * b
```

```asm
; @launch grid=(256,1,1) block=(512,1,1) lds=163840
.amdgcn_target "amdgcn-amd-amdhsa--gfx950"
.text
.globl gated_mix__mha_block__softmax_full_mha__prompt_kernel
.p2align 8
.type gated_mix__mha_block__softmax_full_mha__prompt_kernel,@function
gated_mix__mha_block__softmax_full_mha__prompt_kernel:
  s_cmp_ge_u32 s2, 256
  s_cbranch_scc1 L_end
  s_load_dwordx16 s[8:23], s[0:1], 0
  s_load_dwordx4 s[24:27], s[0:1], 64
  v_and_b32 v1, 63, v0
  v_lshrrev_b32 v2, 6, v0
  s_getreg_b32 s69, hwreg(HW_REG_XCC_ID)
  s_getreg_b32 s70, hwreg(HW_REG_HW_ID)
  v_readfirstlane_b32 s6, v2
  s_and_b32 s69, s69, 7
  v_lshlrev_b32 v2, 4, v1
  v_lshrrev_b32 v3, 3, v1
  v_lshrrev_b32 v4, 1, v3
  v_and_b32 v5, 7, v1
  v_xor_b32 v4, v4, v5
  v_lshlrev_b32 v4, 4, v4
  v_mul_u32_u24 v3, 896, v3
  v_add_u32 v3, v3, v4
  v_xor_b32 v4, 64, v3
  v_lshrrev_b32 v5, 3, v1
  v_bfe_u32 v6, v1, 2, 1
  v_bfe_u32 v7, v1, 4, 1
  v_xor_b32 v6, v6, v7
  v_mul_u32_u24 v6, 896, v6
  v_mul_u32_u24 v5, 2688, v5
  v_add_u32 v5, v5, v6
  v_and_b32 v6, 3, v1
  v_lshlrev_b32 v6, 4, v6
  v_add_u32 v5, v5, v6
  v_add_u32 v5, 896, v5
  v_lshrrev_b32 v7, 2, v1
  v_mul_u32_u24 v7, 2688, v7
  v_add_u32 v6, v7, v6
  s_lshl_b32 s40, s6, 12
  s_lshl_b32 s61, s6, 10
  s_and_b32 s69, s2, 7
  s_lshr_b32 s70, s2, 3
  s_lshr_b32 s3, s69, 1
  s_lshl_b32 s3, s3, 3
  s_and_b32 s4, s70, 7
  s_add_u32 s3, s3, s4
  s_and_b32 s5, s69, 1
  s_lshl_b32 s5, s5, 2
  s_lshr_b32 s4, s70, 3
  s_add_u32 s5, s5, s4
  s_and_b32 s7, s3, 15
  s_lshl_b32 s41, s5, 3
  s_add_u32 s41, s41, s6
  s_mul_i32 s42, s41, 28672
  s_mul_i32 s43, s7, 56
  s_cmp_eq_u32 s7, 15
  s_cselect_b32 s4, 8, 0
  s_sub_u32 s43, s43, s4
  s_mul_i32 s50, s6, 21504
  s_add_u32 s50, s50, s43
  s_mul_i32 s51, s6, 172032
  s_add_u32 s51, s51, s43
  s_and_b32 s71, s70, 7
  s_lshr_b32 s68, s70, 3
  s_lshl_b32 s68, s68, 1
  s_add_u32 s71, s71, s68
  s_cmp_ge_u32 s71, 7
  s_cselect_b32 s68, 7, 0
  s_sub_u32 s71, s71, s68
  s_cmp_ge_u32 s71, 7
  s_cselect_b32 s68, 7, 0
  s_sub_u32 s71, s71, s68
  s_mov_b32 s59, s71
  s_mov_b32 s52, s71
  s_waitcnt lgkmcnt(0)
  s_mov_b32 s28, s8
  s_mov_b32 s29, s9
  s_mov_b32 s30, 1835008
  s_mov_b32 s31, 0x20000
  s_cmp_ge_u32 s3, 16
  s_cselect_b32 s32, s16, s10
  s_cselect_b32 s33, s17, s11
  s_mov_b32 s34, 1204224
  s_mov_b32 s35, 0x20000
  s_cselect_b32 s60, 0, 0x80000000
  s_xor_b32 s60, s60, 0x3fb8aa3b
  s_lshl_b32 s64, s52, 13
  s_add_u32 s64, s64, s61
  s_add_u32 m0, s64, 98304
  s_mul_i32 s68, s52, 172032
  s_add_u32 s68, s68, s50
  buffer_load_dwordx4 v5, s[32:35], s68 offen lds
  s_add_u32 s52, s52, 1
  s_cmp_eq_u32 s52, 7
  s_cselect_b32 s52, 0, s52
  s_add_u32 m0, s40, 0
  s_lshl_b32 s65, s71, 7
  s_add_u32 s65, s65, s42
  buffer_load_dwordx4 v3, s[28:31], s65 offen offset:0 lds
  s_add_u32 m0, s40, 0
  s_add_u32 s65, s65, 6144
  buffer_load_dwordx4 v4, s[28:31], s65 offen offset:1024 lds
  s_add_u32 m0, s40, 0
  s_add_u32 s65, s65, 6144
  buffer_load_dwordx4 v3, s[28:31], s65 offen offset:2048 lds
  s_add_u32 m0, s40, 0
  s_add_u32 s65, s65, 6144
  buffer_load_dwordx4 v4, s[28:31], s65 offen offset:3072 lds
  s_add_u32 s71, s71, 1
  s_cmp_eq_u32 s71, 7
  s_cselect_b32 s71, 0, s71
  s_lshl_b32 s64, s52, 13
  s_add_u32 s64, s64, s61
  s_add_u32 m0, s64, 98304
  s_mul_i32 s68, s52, 172032
  s_add_u32 s68, s68, s50
  buffer_load_dwordx4 v5, s[32:35], s68 offen lds
  s_add_u32 s52, s52, 1
  s_cmp_eq_u32 s52, 7
  s_cselect_b32 s52, 0, s52
  s_barrier
  s_mov_b32 s36, s26
  s_mov_b32 s37, s27
  s_mov_b32 s38, 14680064
  s_mov_b32 s39, 0x20000
  s_mov_b32 s72, s24
  s_mov_b32 s73, s25
  s_mov_b32 s74, 256
  s_mov_b32 s75, 0x20000
  s_or_b32 s58, s2, s6
  s_cmp_lg_u32 s58, 0
  s_cbranch_scc1 L_nononce
  s_memrealtime s[56:57]
  s_waitcnt lgkmcnt(0)
  s_or_b32 s56, s56, 1
  v_mov_b32 v8, s56
  v_mov_b32 v9, s57
  v_mov_b32 v10, 0
  s_mov_b64 exec, 1
  buffer_store_dwordx2 v[8:9], v10, s[72:75], 0 offen sc1
  s_mov_b64 exec, -1
L_nononce:
  s_lshl_b32 s64, s52, 13
  s_add_u32 s64, s64, s61
  s_add_u32 m0, s64, 98304
  s_mul_i32 s68, s52, 172032
  s_add_u32 s68, s68, s50
  buffer_load_dwordx4 v5, s[32:35], s68 offen lds
  s_add_u32 s52, s52, 1
  s_cmp_eq_u32 s52, 7
  s_cselect_b32 s52, 0, s52
  s_add_u32 m0, s40, 32768
  s_lshl_b32 s65, s71, 7
  s_add_u32 s65, s65, s42
  buffer_load_dwordx4 v3, s[28:31], s65 offen offset:0 lds
  s_add_u32 m0, s40, 32768
  s_add_u32 s65, s65, 6144
  buffer_load_dwordx4 v4, s[28:31], s65 offen offset:1024 lds
  s_add_u32 m0, s40, 32768
  s_add_u32 s65, s65, 6144
  buffer_load_dwordx4 v3, s[28:31], s65 offen offset:2048 lds
  s_add_u32 m0, s40, 32768
  s_add_u32 s65, s65, 6144
  buffer_load_dwordx4 v4, s[28:31], s65 offen offset:3072 lds
  s_add_u32 s71, s71, 1
  s_cmp_eq_u32 s71, 7
  s_cselect_b32 s71, 0, s71
  s_mov_b32 s44, s20
  s_mov_b32 s45, s21
  s_mov_b32 s46, 896
  s_mov_b32 s47, 0x20000
  s_lshr_b32 s64, s4, 2
  v_lshlrev_b32 v8, 1, v0
  v_subrev_u32 v8, s64, v8
  buffer_load_ushort v216, v8, s[44:47], 0 offen
  v_and_b32 v16, 31, v1
  v_bfe_u32 v17, v1, 1, 3
  v_lshrrev_b32 v18, 5, v1
  v_lshlrev_b32 v19, 2, v18
  v_xor_b32 v17, v17, v19
  v_lshlrev_b32 v17, 4, v17
  v_lshlrev_b32 v16, 7, v16
  v_add_u32 v16, v16, v17
  v_add_u32 v8, s40, v16
  v_xor_b32 v9, 16, v8
  v_xor_b32 v10, 32, v8
  v_xor_b32 v11, 48, v8
  v_add_u32 v12, 0x10000, v8
  v_add_u32 v13, 0x10000, v9
  v_add_u32 v14, 0x10000, v10
  v_add_u32 v15, 0x10000, v11
  v_lshlrev_b32 v16, 5, v18
  v_bfe_u32 v17, v1, 2, 2
  v_add_u32 v16, v16, v17
  v_bfe_u32 v19, v1, 4, 1
  v_lshlrev_b32 v19, 5, v19
  v_and_b32 v20, 3, v1
  v_lshlrev_b32 v20, 3, v20
  v_add_u32 v19, v19, v20
  v_lshlrev_b32 v20, 7, v16
  v_add_u32 v20, v20, v19
  v_bfe_u32 v21, v1, 3, 1
  v_lshlrev_b32 v21, 6, v21
  v_add_u32 v20, v20, v21
  v_add_u32 v232, 98304, v20
  v_xor_b32 v233, 64, v232
  v_add_u32 v232, s4, v232
  v_add_u32 v233, s4, v233
  v_lshlrev_b32 v20, 6, v16
  v_add_u32 v20, v20, v19
  v_add_u32 v234, 32768, v20
  v_add_u32 v234, s4, v234
  v_lshlrev_b32 v217, 6, v0
  v_add_u32 v217, 32824, v217
  s_mul_i32 s64, s4, 7
  v_subrev_u32 v217, s64, v217
  s_mov_b32 s62, 0
  s_mov_b32 s63, -1
  v_mov_b32 v235, 0
  s_lshl_b32 s64, s3, 18
  s_lshl_b32 s66, s5, 15
  s_add_u32 s64, s64, s66
  s_lshl_b32 s66, s41, 16
  s_add_u32 s66, s66, 8388608
  s_and_b32 s67, s6, 3
  s_cmp_eq_u32 s67, 1
  s_cselect_b32 s64, s66, s64
  s_cmp_eq_u32 s67, 2
  s_cselect_b32 s64, 12591104, s64
  s_lshl_b32 s66, s69, 19
  s_add_u32 s66, s66, 8388608
  s_cmp_eq_u32 s67, 3
  s_cselect_b32 s64, s66, s64
  buffer_load_dword v219, v235, s[36:39], s64 offen sc1
  s_mul_i32 s53, s69, 229376
  s_mov_b32 s64, s22
  s_mov_b32 s65, s23
  s_mov_b32 s66, 1835008
  s_mov_b32 s67, 0x20000
  buffer_load_dword v219, v235, s[64:67], s53 offen
  s_lshr_b32 s7, s6, 1
  s_and_b32 s96, s6, 1
  s_lshl_b32 s64, s96, 14
  v_add_u32 v244, s64, v2
  v_add_u32 v245, s40, v2
  s_lshl_b32 s66, s7, 12
  s_add_u32 s66, s66, 98304
  v_add_u32 v248, s66, v2
  v_and_b32 v249, 7, v1
  v_lshlrev_b32 v249, 3, v249
  s_lshl_b32 s97, s3, 7
  s_add_u32 s97, s97, 12591104
  s_lshl_b32 s98, s3, 18
  s_add_u32 s98, s98, s40
  s_add_u32 s99, s5, 1
  s_mov_b32 s49, 0
  s_lshl_b32 s54, s69, 2
  s_and_b32 s55, s70, 3
  s_add_u32 s54, s54, s55
  s_lshr_b32 s55, s70, 2
  v_lshrrev_b32 v251, 3, v1
  v_bfe_u32 v16, v251, 1, 1
  v_lshlrev_b32 v16, 2, v16
  v_and_b32 v17, 7, v1
  v_xor_b32 v16, v16, v17
  v_lshlrev_b32 v16, 4, v16
  v_mul_u32_u24 v251, 896, v251
  v_add_u32 v251, v251, v16
  s_mul_i32 s100, s55, 112
  s_mul_i32 s101, s6, 7168
  s_add_u32 s100, s100, s101
  s_mov_b32 s101, s100
  s_add_u32 s43, s61, 98304
  s_mov_b32 s44, s18
  s_mov_b32 s45, s19
  s_mov_b32 s46, 401408
  s_mov_b32 s47, 0x20000
  s_lshl_b32 s48, s3, 18
  s_lshl_b32 s53, s5, 15
  s_add_u32 s48, s48, s53
  s_add_u32 s48, s48, s40
  s_add_u32 s67, s40, 65536
  v_add_u32 v238, s67, v2
  s_lshl_b32 s66, s6, 11
  s_add_u32 s66, s66, 98304
  v_add_u32 v218, s66, v2
  v_and_b32 v240, 31, v1
  v_mov_b32 v239, 0x3f803f80
  v_cmp_eq_u32 vcc, 28, v240
  s_nop 1
  v_cndmask_b32 v239, 0, v239, vcc
  s_waitcnt vmcnt(8)
  s_barrier
  s_lshl_b32 s64, s59, 13
  v_add_u32 v242, s64, v232
  v_add_u32 v243, s64, v233
  s_add_u32 s59, s59, 1
  s_cmp_eq_u32 s59, 7
  s_cselect_b32 s59, 0, s59
  ds_read_b64_tr_b16 v[176:177], v242 offset:0
  ds_read_b64_tr_b16 v[178:179], v242 offset:512
  ds_read_b64_tr_b16 v[180:181], v243 offset:0
  ds_read_b64_tr_b16 v[182:183], v243 offset:512
  ds_read_b128 v[64:67], v8 offset:0
  ds_read_b128 v[68:71], v9 offset:0
  ds_read_b128 v[72:75], v10 offset:0
  ds_read_b128 v[76:79], v11 offset:0
  ds_read_b64_tr_b16 v[184:185], v242 offset:1024
  ds_read_b64_tr_b16 v[186:187], v242 offset:1536
  ds_read_b64_tr_b16 v[188:189], v243 offset:1024
  ds_read_b64_tr_b16 v[190:191], v243 offset:1536
  s_lshl_b32 s64, s52, 13
  s_add_u32 s64, s64, s61
  s_add_u32 m0, s64, 98304
  s_mul_i32 s68, s52, 172032
  s_add_u32 s68, s68, s50
  buffer_load_dwordx4 v5, s[32:35], s68 offen lds
  s_add_u32 s52, s52, 1
  s_cmp_eq_u32 s52, 7
  s_cselect_b32 s52, 0, s52
  ds_read_b64_tr_b16 v[192:193], v242 offset:2048
  ds_read_b64_tr_b16 v[194:195], v242 offset:2560
  ds_read_b64_tr_b16 v[196:197], v243 offset:2048
  ds_read_b64_tr_b16 v[198:199], v243 offset:2560
  s_waitcnt lgkmcnt(8)
  v_mfma_f32_32x32x16_bf16 v[32:47], v[176:179], v[64:67], 0
  v_mfma_f32_32x32x16_bf16 v[48:63], v[64:67], v[180:183], 0
  s_add_u32 m0, s40, 65536
  s_lshl_b32 s65, s71, 7
  s_add_u32 s65, s65, s42
  buffer_load_dwordx4 v3, s[28:31], s65 offen offset:0 lds
  ds_read_b64_tr_b16 v[176:177], v242 offset:3072
  ds_read_b64_tr_b16 v[178:179], v242 offset:3584
  ds_read_b64_tr_b16 v[180:181], v243 offset:3072
  ds_read_b64_tr_b16 v[182:183], v243 offset:3584
  s_waitcnt lgkmcnt(8)
  v_mfma_f32_32x32x16_bf16 v[32:47], v[184:187], v[68:71], v[32:47]
  v_mfma_f32_32x32x16_bf16 v[48:63], v[68:71], v[188:191], v[48:63]
  s_add_u32 m0, s40, 65536
  s_add_u32 s65, s65, 6144
  buffer_load_dwordx4 v4, s[28:31], s65 offen offset:1024 lds
  s_lshl_b32 s64, s59, 13
  v_add_u32 v246, s64, v232
  v_add_u32 v247, s64, v233
  s_add_u32 s59, s59, 1
  s_cmp_eq_u32 s59, 7
  s_cselect_b32 s59, 0, s59
  ds_read_b64_tr_b16 v[184:185], v246 offset:0
  ds_read_b64_tr_b16 v[186:187], v246 offset:512
  ds_read_b64_tr_b16 v[188:189], v247 offset:0
  ds_read_b64_tr_b16 v[190:191], v247 offset:512
  s_waitcnt lgkmcnt(8)
  v_mfma_f32_32x32x16_bf16 v[32:47], v[192:195], v[72:75], v[32:47]
  v_mfma_f32_32x32x16_bf16 v[48:63], v[72:75], v[196:199], v[48:63]
  s_add_u32 m0, s40, 65536
  s_add_u32 s65, s65, 6144
  buffer_load_dwordx4 v3, s[28:31], s65 offen offset:2048 lds
  s_add_u32 m0, s40, 65536
  s_add_u32 s65, s65, 6144
  buffer_load_dwordx4 v4, s[28:31], s65 offen offset:3072 lds
  s_add_u32 s71, s71, 1
  s_cmp_eq_u32 s71, 7
  s_cselect_b32 s71, 0, s71
  ds_read_b64_tr_b16 v[192:193], v246 offset:1024
  ds_read_b64_tr_b16 v[194:195], v246 offset:1536
  ds_read_b64_tr_b16 v[196:197], v247 offset:1024
  ds_read_b64_tr_b16 v[198:199], v247 offset:1536
  s_waitcnt lgkmcnt(8)
  v_mfma_f32_32x32x16_bf16 v[32:47], v[176:179], v[76:79], v[32:47]
  v_mfma_f32_32x32x16_bf16 v[48:63], v[76:79], v[180:183], v[48:63]
  s_waitcnt vmcnt(8)
  s_barrier
  ds_read_b128 v[80:83], v8 offset:32768
  ds_read_b128 v[84:87], v9 offset:32768
  ds_read_b128 v[88:91], v10 offset:32768
  ds_read_b128 v[92:95], v11 offset:32768
  s_lshl_b32 s64, s52, 13
  s_add_u32 s64, s64, s61
  s_add_u32 m0, s64, 98304
  s_mul_i32 s68, s52, 172032
  s_add_u32 s68, s68, s50
  buffer_load_dwordx4 v5, s[32:35], s68 offen lds
  s_add_u32 s52, s52, 1
  s_cmp_eq_u32 s52, 7
  s_cselect_b32 s52, 0, s52
  ds_read_b64_tr_b16 v[176:177], v246 offset:2048
  ds_read_b64_tr_b16 v[178:179], v246 offset:2560
  ds_read_b64_tr_b16 v[180:181], v247 offset:2048
  ds_read_b64_tr_b16 v[182:183], v247 offset:2560
  s_waitcnt lgkmcnt(4)
  v_mfma_f32_32x32x16_bf16 v[32:47], v[184:187], v[80:83], v[32:47]
  v_mfma_f32_32x32x16_bf16 v[48:63], v[80:83], v[188:191], v[48:63]
  s_add_u32 m0, s40, 0
  s_lshl_b32 s65, s71, 7
  s_add_u32 s65, s65, s42
  buffer_load_dwordx4 v3, s[28:31], s65 offen offset:0 lds
  ds_read_b64_tr_b16 v[184:185], v246 offset:3072
  ds_read_b64_tr_b16 v[186:187], v246 offset:3584
  ds_read_b64_tr_b16 v[188:189], v247 offset:3072
  ds_read_b64_tr_b16 v[190:191], v247 offset:3584
  s_waitcnt lgkmcnt(8)
  v_mfma_f32_32x32x16_bf16 v[32:47], v[192:195], v[84:87], v[32:47]
  v_mfma_f32_32x32x16_bf16 v[48:63], v[84:87], v[196:199], v[48:63]
  s_add_u32 m0, s40, 0
  s_add_u32 s65, s65, 6144
  buffer_load_dwordx4 v4, s[28:31], s65 offen offset:1024 lds
  s_lshl_b32 s64, s59, 13
  v_add_u32 v242, s64, v232
  v_add_u32 v243, s64, v233
  s_add_u32 s59, s59, 1
  s_cmp_eq_u32 s59, 7
  s_cselect_b32 s59, 0, s59
  ds_read_b64_tr_b16 v[192:193], v242 offset:0
  ds_read_b64_tr_b16 v[194:195], v242 offset:512
  ds_read_b64_tr_b16 v[196:197], v243 offset:0
  ds_read_b64_tr_b16 v[198:199], v243 offset:512
  s_waitcnt lgkmcnt(8)
  v_mfma_f32_32x32x16_bf16 v[32:47], v[176:179], v[88:91], v[32:47]
  v_mfma_f32_32x32x16_bf16 v[48:63], v[88:91], v[180:183], v[48:63]
  s_add_u32 m0, s40, 0
  s_add_u32 s65, s65, 6144
  buffer_load_dwordx4 v3, s[28:31], s65 offen offset:2048 lds
  s_add_u32 m0, s40, 0
  s_add_u32 s65, s65, 6144
  buffer_load_dwordx4 v4, s[28:31], s65 offen offset:3072 lds
  s_add_u32 s71, s71, 1
  s_cmp_eq_u32 s71, 7
  s_cselect_b32 s71, 0, s71
  ds_read_b64_tr_b16 v[176:177], v242 offset:1024
  ds_read_b64_tr_b16 v[178:179], v242 offset:1536
  ds_read_b64_tr_b16 v[180:181], v243 offset:1024
  ds_read_b64_tr_b16 v[182:183], v243 offset:1536
  s_waitcnt lgkmcnt(8)
  v_mfma_f32_32x32x16_bf16 v[32:47], v[184:187], v[92:95], v[32:47]
  v_mfma_f32_32x32x16_bf16 v[48:63], v[92:95], v[188:191], v[48:63]
  s_waitcnt vmcnt(5)
  s_barrier
  ds_read_b128 v[96:99], v12 offset:0
  ds_read_b128 v[100:103], v13 offset:0
  ds_read_b128 v[104:107], v14 offset:0
  ds_read_b128 v[108:111], v15 offset:0
  s_lshl_b32 s64, s52, 13
  s_add_u32 s64, s64, s61
  s_add_u32 m0, s64, 98304
  s_mul_i32 s68, s52, 172032
  s_add_u32 s68, s68, s50
  buffer_load_dwordx4 v5, s[32:35], s68 offen lds
  s_add_u32 s52, s52, 1
  s_cmp_eq_u32 s52, 7
  s_cselect_b32 s52, 0, s52
  ds_read_b64_tr_b16 v[184:185], v242 offset:2048
  ds_read_b64_tr_b16 v[186:187], v242 offset:2560
  ds_read_b64_tr_b16 v[188:189], v243 offset:2048
  ds_read_b64_tr_b16 v[190:191], v243 offset:2560
  s_waitcnt lgkmcnt(4)
  v_mfma_f32_32x32x16_bf16 v[32:47], v[192:195], v[96:99], v[32:47]
  v_mfma_f32_32x32x16_bf16 v[48:63], v[96:99], v[196:199], v[48:63]
  s_add_u32 m0, s40, 32768
  s_lshl_b32 s65, s71, 7
  s_add_u32 s65, s65, s42
  buffer_load_dwordx4 v3, s[28:31], s65 offen offset:0 lds
  ds_read_b64_tr_b16 v[192:193], v242 offset:3072
  ds_read_b64_tr_b16 v[194:195], v242 offset:3584
  ds_read_b64_tr_b16 v[196:197], v243 offset:3072
  ds_read_b64_tr_b16 v[198:199], v243 offset:3584
  s_waitcnt lgkmcnt(8)
  v_mfma_f32_32x32x16_bf16 v[32:47], v[176:179], v[100:103], v[32:47]
  v_mfma_f32_32x32x16_bf16 v[48:63], v[100:103], v[180:183], v[48:63]
  s_add_u32 m0, s40, 32768
  s_add_u32 s65, s65, 6144
  buffer_load_dwordx4 v4, s[28:31], s65 offen offset:1024 lds
  s_lshl_b32 s64, s59, 13
  v_add_u32 v246, s64, v232
  v_add_u32 v247, s64, v233
  s_add_u32 s59, s59, 1
  s_cmp_eq_u32 s59, 7
  s_cselect_b32 s59, 0, s59
  ds_read_b64_tr_b16 v[176:177], v246 offset:0
  ds_read_b64_tr_b16 v[178:179], v246 offset:512
  ds_read_b64_tr_b16 v[180:181], v247 offset:0
  ds_read_b64_tr_b16 v[182:183], v247 offset:512
  s_waitcnt lgkmcnt(8)
  v_mfma_f32_32x32x16_bf16 v[32:47], v[184:187], v[104:107], v[32:47]
  v_mfma_f32_32x32x16_bf16 v[48:63], v[104:107], v[188:191], v[48:63]
  s_add_u32 m0, s40, 32768
  s_add_u32 s65, s65, 6144
  buffer_load_dwordx4 v3, s[28:31], s65 offen offset:2048 lds
  s_add_u32 m0, s40, 32768
  s_add_u32 s65, s65, 6144
  buffer_load_dwordx4 v4, s[28:31], s65 offen offset:3072 lds
  s_add_u32 s71, s71, 1
  s_cmp_eq_u32 s71, 7
  s_cselect_b32 s71, 0, s71
  ds_read_b64_tr_b16 v[184:185], v246 offset:1024
  ds_read_b64_tr_b16 v[186:187], v246 offset:1536
  ds_read_b64_tr_b16 v[188:189], v247 offset:1024
  ds_read_b64_tr_b16 v[190:191], v247 offset:1536
  s_waitcnt lgkmcnt(8)
  v_mfma_f32_32x32x16_bf16 v[32:47], v[192:195], v[108:111], v[32:47]
  v_mfma_f32_32x32x16_bf16 v[48:63], v[108:111], v[196:199], v[48:63]
  s_waitcnt vmcnt(5)
  s_barrier
  ds_read_b128 v[112:115], v8 offset:0
  ds_read_b128 v[116:119], v9 offset:0
  ds_read_b128 v[120:123], v10 offset:0
  ds_read_b128 v[124:127], v11 offset:0
  s_lshl_b32 s64, s52, 13
  s_add_u32 s64, s64, s61
  s_add_u32 m0, s64, 98304
  s_mul_i32 s68, s52, 172032
  s_add_u32 s68, s68, s50
  buffer_load_dwordx4 v5, s[32:35], s68 offen lds
  s_add_u32 s52, s52, 1
  s_cmp_eq_u32 s52, 7
  s_cselect_b32 s52, 0, s52
  ds_read_b64_tr_b16 v[192:193], v246 offset:2048
  ds_read_b64_tr_b16 v[194:195], v246 offset:2560
  ds_read_b64_tr_b16 v[196:197], v247 offset:2048
  ds_read_b64_tr_b16 v[198:199], v247 offset:2560
  s_waitcnt lgkmcnt(4)
  v_mfma_f32_32x32x16_bf16 v[32:47], v[176:179], v[112:115], v[32:47]
  v_mfma_f32_32x32x16_bf16 v[48:63], v[112:115], v[180:183], v[48:63]
  s_add_u32 m0, s40, 65536
  s_lshl_b32 s65, s71, 7
  s_add_u32 s65, s65, s42
  buffer_load_dwordx4 v3, s[28:31], s65 offen offset:0 lds
  ds_read_b64_tr_b16 v[176:177], v246 offset:3072
  ds_read_b64_tr_b16 v[178:179], v246 offset:3584
  ds_read_b64_tr_b16 v[180:181], v247 offset:3072
  ds_read_b64_tr_b16 v[182:183], v247 offset:3584
  s_waitcnt lgkmcnt(8)
  v_mfma_f32_32x32x16_bf16 v[32:47], v[184:187], v[116:119], v[32:47]
  v_mfma_f32_32x32x16_bf16 v[48:63], v[116:119], v[188:191], v[48:63]
  s_add_u32 m0, s40, 65536
  s_add_u32 s65, s65, 6144
  buffer_load_dwordx4 v4, s[28:31], s65 offen offset:1024 lds
  s_lshl_b32 s64, s59, 13
  v_add_u32 v242, s64, v232
  v_add_u32 v243, s64, v233
  s_add_u32 s59, s59, 1
  s_cmp_eq_u32 s59, 7
  s_cselect_b32 s59, 0, s59
  ds_read_b64_tr_b16 v[184:185], v242 offset:0
  ds_read_b64_tr_b16 v[186:187], v242 offset:512
  ds_read_b64_tr_b16 v[188:189], v243 offset:0
  ds_read_b64_tr_b16 v[190:191], v243 offset:512
  s_waitcnt lgkmcnt(8)
  v_mfma_f32_32x32x16_bf16 v[32:47], v[192:195], v[120:123], v[32:47]
  v_mfma_f32_32x32x16_bf16 v[48:63], v[120:123], v[196:199], v[48:63]
  s_add_u32 m0, s40, 65536
  s_add_u32 s65, s65, 6144
  buffer_load_dwordx4 v3, s[28:31], s65 offen offset:2048 lds
  s_add_u32 m0, s40, 65536
  s_add_u32 s65, s65, 6144
  buffer_load_dwordx4 v4, s[28:31], s65 offen offset:3072 lds
  s_add_u32 s71, s71, 1
  s_cmp_eq_u32 s71, 7
  s_cselect_b32 s71, 0, s71
  ds_read_b64_tr_b16 v[192:193], v242 offset:1024
  ds_read_b64_tr_b16 v[194:195], v242 offset:1536
  ds_read_b64_tr_b16 v[196:197], v243 offset:1024
  ds_read_b64_tr_b16 v[198:199], v243 offset:1536
  s_waitcnt lgkmcnt(8)
  v_mfma_f32_32x32x16_bf16 v[32:47], v[176:179], v[124:127], v[32:47]
  v_mfma_f32_32x32x16_bf16 v[48:63], v[124:127], v[180:183], v[48:63]
  s_waitcnt vmcnt(5)
  s_barrier
  ds_read_b128 v[128:131], v8 offset:32768
  ds_read_b128 v[132:135], v9 offset:32768
  ds_read_b128 v[136:139], v10 offset:32768
  ds_read_b128 v[140:143], v11 offset:32768
  s_add_u32 m0, s40, 0
  s_lshl_b32 s65, s71, 7
  s_add_u32 s65, s65, s42
  buffer_load_dwordx4 v3, s[28:31], s65 offen offset:0 lds
  ds_read_b64_tr_b16 v[176:177], v242 offset:2048
  ds_read_b64_tr_b16 v[178:179], v242 offset:2560
  ds_read_b64_tr_b16 v[180:181], v243 offset:2048
  ds_read_b64_tr_b16 v[182:183], v243 offset:2560
  s_waitcnt lgkmcnt(4)
  v_mfma_f32_32x32x16_bf16 v[32:47], v[184:187], v[128:131], v[32:47]
  v_mfma_f32_32x32x16_bf16 v[48:63], v[128:131], v[188:191], v[48:63]
  s_add_u32 m0, s40, 0
  s_add_u32 s65, s65, 6144
  buffer_load_dwordx4 v4, s[28:31], s65 offen offset:1024 lds
  ds_read_b64_tr_b16 v[184:185], v242 offset:3072
  ds_read_b64_tr_b16 v[186:187], v242 offset:3584
  ds_read_b64_tr_b16 v[188:189], v243 offset:3072
  ds_read_b64_tr_b16 v[190:191], v243 offset:3584
  s_waitcnt lgkmcnt(8)
  v_mfma_f32_32x32x16_bf16 v[32:47], v[192:195], v[132:135], v[32:47]
  v_mfma_f32_32x32x16_bf16 v[48:63], v[132:135], v[196:199], v[48:63]
  s_add_u32 m0, s40, 0
  s_add_u32 s65, s65, 6144
  buffer_load_dwordx4 v3, s[28:31], s65 offen offset:2048 lds
  s_lshl_b32 s64, s59, 13
  v_add_u32 v246, s64, v232
  v_add_u32 v247, s64, v233
  s_add_u32 s59, s59, 1
  s_cmp_eq_u32 s59, 7
  s_cselect_b32 s59, 0, s59
  ds_read_b64_tr_b16 v[192:193], v246 offset:0
  ds_read_b64_tr_b16 v[194:195], v246 offset:512
  ds_read_b64_tr_b16 v[196:197], v247 offset:0
  ds_read_b64_tr_b16 v[198:199], v247 offset:512
  s_waitcnt lgkmcnt(8)
  v_mfma_f32_32x32x16_bf16 v[32:47], v[176:179], v[136:139], v[32:47]
  v_mfma_f32_32x32x16_bf16 v[48:63], v[136:139], v[180:183], v[48:63]
  s_add_u32 m0, s40, 0
  s_add_u32 s65, s65, 6144
  buffer_load_dwordx4 v4, s[28:31], s65 offen offset:3072 lds
  s_add_u32 s71, s71, 1
  s_cmp_eq_u32 s71, 7
  s_cselect_b32 s71, 0, s71
  buffer_load_dwordx2 v[236:237], v235, s[72:75], 0 offen sc1
  ds_read_b64_tr_b16 v[176:177], v246 offset:1024
  ds_read_b64_tr_b16 v[178:179], v246 offset:1536
  ds_read_b64_tr_b16 v[180:181], v247 offset:1024
  ds_read_b64_tr_b16 v[182:183], v247 offset:1536
  s_waitcnt lgkmcnt(8)
  v_mfma_f32_32x32x16_bf16 v[32:47], v[184:187], v[140:143], v[32:47]
  v_mfma_f32_32x32x16_bf16 v[48:63], v[140:143], v[188:191], v[48:63]
  s_waitcnt vmcnt(5)
  s_barrier
  ds_read_b128 v[144:147], v12 offset:0
  ds_read_b128 v[148:151], v13 offset:0
  ds_read_b128 v[152:155], v14 offset:0
  ds_read_b128 v[156:159], v15 offset:0
  s_add_u32 m0, s40, 32768
  s_add_u32 s68, s51, 0
  buffer_load_dwordx4 v6, s[32:35], s68 offen lds
  ds_read_b64_tr_b16 v[184:185], v246 offset:2048
  ds_read_b64_tr_b16 v[186:187], v246 offset:2560
  ds_read_b64_tr_b16 v[188:189], v247 offset:2048
  ds_read_b64_tr_b16 v[190:191], v247 offset:2560
  s_waitcnt lgkmcnt(4)
  v_mfma_f32_32x32x16_bf16 v[32:47], v[192:195], v[144:147], v[32:47]
  v_mfma_f32_32x32x16_bf16 v[48:63], v[144:147], v[196:199], v[48:63]
  s_add_u32 m0, s40, 33792
  s_add_u32 s68, s51, 43008
  buffer_load_dwordx4 v6, s[32:35], s68 offen lds
  ds_read_b64_tr_b16 v[192:193], v246 offset:3072
  ds_read_b64_tr_b16 v[194:195], v246 offset:3584
  ds_read_b64_tr_b16 v[196:197], v247 offset:3072
  ds_read_b64_tr_b16 v[198:199], v247 offset:3584
  s_waitcnt lgkmcnt(8)
  v_mfma_f32_32x32x16_bf16 v[32:47], v[176:179], v[148:151], v[32:47]
  v_mfma_f32_32x32x16_bf16 v[48:63], v[148:151], v[180:183], v[48:63]
  s_add_u32 m0, s40, 34816
  s_add_u32 s68, s51, 86016
  buffer_load_dwordx4 v6, s[32:35], s68 offen lds
  s_lshl_b32 s64, s59, 13
  v_add_u32 v242, s64, v232
  v_add_u32 v243, s64, v233
  s_add_u32 s59, s59, 1
  s_cmp_eq_u32 s59, 7
  s_cselect_b32 s59, 0, s59
  ds_read_b64_tr_b16 v[176:177], v242 offset:0
  ds_read_b64_tr_b16 v[178:179], v242 offset:512
  ds_read_b64_tr_b16 v[180:181], v243 offset:0
  ds_read_b64_tr_b16 v[182:183], v243 offset:512
  s_waitcnt lgkmcnt(8)
  v_mfma_f32_32x32x16_bf16 v[32:47], v[184:187], v[152:155], v[32:47]
  v_mfma_f32_32x32x16_bf16 v[48:63], v[152:155], v[188:191], v[48:63]
  s_add_u32 m0, s40, 35840
  s_add_u32 s68, s51, 129024
  buffer_load_dwordx4 v6, s[32:35], s68 offen lds
  ds_read_b64_tr_b16 v[184:185], v242 offset:1024
  ds_read_b64_tr_b16 v[186:187], v242 offset:1536
  ds_read_b64_tr_b16 v[188:189], v243 offset:1024
  ds_read_b64_tr_b16 v[190:191], v243 offset:1536
  s_waitcnt lgkmcnt(8)
  v_mfma_f32_32x32x16_bf16 v[32:47], v[192:195], v[156:159], v[32:47]
  v_mfma_f32_32x32x16_bf16 v[48:63], v[156:159], v[196:199], v[48:63]
  s_waitcnt vmcnt(5)
  ds_read_b128 v[160:163], v8 offset:0
  ds_read_b128 v[164:167], v9 offset:0
  ds_read_b128 v[168:171], v10 offset:0
  ds_read_b128 v[172:175], v11 offset:0
  ds_read_b64_tr_b16 v[192:193], v242 offset:2048
  ds_read_b64_tr_b16 v[194:195], v242 offset:2560
  ds_read_b64_tr_b16 v[196:197], v243 offset:2048
  ds_read_b64_tr_b16 v[198:199], v243 offset:2560
  s_waitcnt lgkmcnt(4)
  v_mfma_f32_32x32x16_bf16 v[32:47], v[176:179], v[160:163], v[32:47]
  v_mfma_f32_32x32x16_bf16 v[48:63], v[160:163], v[180:183], v[48:63]
  ds_read_b64_tr_b16 v[176:177], v242 offset:3072
  ds_read_b64_tr_b16 v[178:179], v242 offset:3584
  ds_read_b64_tr_b16 v[180:181], v243 offset:3072
  ds_read_b64_tr_b16 v[182:183], v243 offset:3584
  s_waitcnt lgkmcnt(8)
  v_mfma_f32_32x32x16_bf16 v[32:47], v[184:187], v[164:167], v[32:47]
  v_mfma_f32_32x32x16_bf16 v[48:63], v[164:167], v[188:191], v[48:63]
  s_waitcnt lgkmcnt(4)
  v_mfma_f32_32x32x16_bf16 v[32:47], v[192:195], v[168:171], v[32:47]
  v_mfma_f32_32x32x16_bf16 v[48:63], v[168:171], v[196:199], v[48:63]
  s_waitcnt lgkmcnt(0)
  v_mfma_f32_32x32x16_bf16 v[32:47], v[176:179], v[172:175], v[32:47]
  v_mfma_f32_32x32x16_bf16 v[48:63], v[172:175], v[180:183], v[48:63]
  s_waitcnt vmcnt(4)
  s_mov_b32 s58, 0
L_nonce:
  v_readfirstlane_b32 s56, v236
  v_readfirstlane_b32 s57, v237
  s_add_u32 s58, s58, 1
  s_cmp_ge_u32 s58, 262144
  s_cbranch_scc1 L_nonce_ok
  s_cmp_lg_u32 s56, 0
  s_cbranch_scc1 L_nonce_ok
  buffer_load_dwordx2 v[236:237], v235, s[72:75], 0 offen sc1
  s_waitcnt vmcnt(0)
  s_branch L_nonce
L_nonce_ok:
  s_mov_b32 s72, s12
  s_mov_b32 s73, s13
  s_mov_b32 s74, 401408
  s_mov_b32 s75, 0x20000
  s_mov_b32 s64, 0xf0000000
  s_mov_b32 s65, 0xf0000000
  s_nop 1
  s_mov_b64 exec, s[62:63]
  v_mov_b32 v44, 1.0
  v_mov_b32 v45, 1.0
  v_mov_b32 v46, 1.0
  v_mov_b32 v47, 0
  s_mov_b64 exec, -1
  v_cvt_pk_bf16_f32 v200, v32, v33
  v_cvt_pk_bf16_f32 v201, v34, v35
  v_cvt_pk_bf16_f32 v202, v36, v37
  v_cvt_pk_bf16_f32 v203, v38, v39
  v_cvt_pk_bf16_f32 v204, v40, v41
  v_cvt_pk_bf16_f32 v205, v42, v43
  v_cvt_pk_bf16_f32 v206, v44, v45
  v_cvt_pk_bf16_f32 v207, v46, v47
  buffer_store_dwordx4 v[200:203], v2, s[36:39], s48 offen sc1
  buffer_store_dwordx4 v[204:207], v2, s[36:39], s48 offen offset:1024 sc1
  v_cvt_pk_bf16_f32 v208, v48, v49
  v_cvt_pk_bf16_f32 v209, v50, v51
  v_cvt_pk_bf16_f32 v210, v52, v53
  v_cvt_pk_bf16_f32 v211, v54, v55
  v_cvt_pk_bf16_f32 v212, v56, v57
  v_cvt_pk_bf16_f32 v213, v58, v59
  v_cvt_pk_bf16_f32 v214, v60, v61
  v_cvt_pk_bf16_f32 v215, v62, v63
  s_mov_b64 exec, s[64:65]
  v_mov_b32 v208, v239
  v_mov_b32 v209, v239
  v_mov_b32 v210, v239
  v_mov_b32 v211, v239
  v_mov_b32 v212, v239
  v_mov_b32 v213, v239
  v_mov_b32 v214, v239
  v_mov_b32 v215, v239
  s_mov_b64 exec, -1
  buffer_store_dwordx4 v[208:211], v2, s[36:39], s48 offen offset:2048 sc1
  buffer_store_dwordx4 v[212:215], v2, s[36:39], s48 offen offset:3072 sc1
  ds_write_b128 v238, v[200:203] offset:0
  ds_write_b128 v238, v[204:207] offset:1024
  ds_write_b128 v238, v[208:211] offset:2048
  ds_write_b128 v238, v[212:215] offset:3072
  s_waitcnt vmcnt(4)
  ds_write_b16 v217, v216
  s_waitcnt lgkmcnt(0)
  s_barrier
  s_lshl_b32 s64, s59, 12
  v_add_u32 v242, s64, v234
  s_add_u32 s59, s59, 1
  s_cmp_eq_u32 s59, 7
  s_cselect_b32 s59, 0, s59
  ds_read_b64_tr_b16 v[176:177], v242 offset:0
  ds_read_b64_tr_b16 v[178:179], v242 offset:256
  ds_read_b64_tr_b16 v[180:181], v242 offset:512
  ds_read_b64_tr_b16 v[182:183], v242 offset:768
  ds_read_b64_tr_b16 v[184:185], v242 offset:1024
  ds_read_b64_tr_b16 v[186:187], v242 offset:1280
  ds_read_b64_tr_b16 v[188:189], v242 offset:1536
  ds_read_b64_tr_b16 v[190:191], v242 offset:1792
  s_waitcnt lgkmcnt(6)
  v_mfma_f32_32x32x16_bf16 v[16:31], v[176:179], v[64:67], 0
  s_lshl_b32 s64, s59, 12
  v_add_u32 v246, s64, v234
  s_add_u32 s59, s59, 1
  s_cmp_eq_u32 s59, 7
  s_cselect_b32 s59, 0, s59
  ds_read_b64_tr_b16 v[176:177], v246 offset:0
  ds_read_b64_tr_b16 v[178:179], v246 offset:256
  s_waitcnt lgkmcnt(6)
  v_mfma_f32_32x32x16_bf16 v[16:31], v[180:183], v[68:71], v[16:31]
  ds_read_b64_tr_b16 v[180:181], v246 offset:512
  ds_read_b64_tr_b16 v[182:183], v246 offset:768
  s_waitcnt lgkmcnt(6)
  v_mfma_f32_32x32x16_bf16 v[16:31], v[184:187], v[72:75], v[16:31]
  ds_read_b64_tr_b16 v[184:185], v246 offset:1024
  ds_read_b64_tr_b16 v[186:187], v246 offset:1280
  s_waitcnt lgkmcnt(6)
  v_mfma_f32_32x32x16_bf16 v[16:31], v[188:191], v[76:79], v[16:31]
  ds_read_b64_tr_b16 v[188:189], v246 offset:1536
  ds_read_b64_tr_b16 v[190:191], v246 offset:1792
  s_waitcnt lgkmcnt(6)
  v_mfma_f32_32x32x16_bf16 v[16:31], v[176:179], v[80:83], v[16:31]
  s_lshl_b32 s64, s59, 12
  v_add_u32 v242, s64, v234
  s_add_u32 s59, s59, 1
  s_cmp_eq_u32 s59, 7
  s_cselect_b32 s59, 0, s59
  ds_read_b64_tr_b16 v[176:177], v242 offset:0
  ds_read_b64_tr_b16 v[178:179], v242 offset:256
  s_waitcnt lgkmcnt(6)
  v_mfma_f32_32x32x16_bf16 v[16:31], v[180:183], v[84:87], v[16:31]
  ds_read_b64_tr_b16 v[180:181], v242 offset:512
  ds_read_b64_tr_b16 v[182:183], v242 offset:768
  s_waitcnt lgkmcnt(6)
  v_mfma_f32_32x32x16_bf16 v[16:31], v[184:187], v[88:91], v[16:31]
  ds_read_b64_tr_b16 v[184:185], v242 offset:1024
  ds_read_b64_tr_b16 v[186:187], v242 offset:1280
  s_waitcnt lgkmcnt(6)
  v_mfma_f32_32x32x16_bf16 v[16:31], v[188:191], v[92:95], v[16:31]
  ds_read_b64_tr_b16 v[188:189], v242 offset:1536
  ds_read_b64_tr_b16 v[190:191], v242 offset:1792
  s_waitcnt lgkmcnt(6)
  v_mfma_f32_32x32x16_bf16 v[16:31], v[176:179], v[96:99], v[16:31]
  s_lshl_b32 s64, s59, 12
  v_add_u32 v246, s64, v234
  s_add_u32 s59, s59, 1
  s_cmp_eq_u32 s59, 7
  s_cselect_b32 s59, 0, s59
  ds_read_b64_tr_b16 v[176:177], v246 offset:0
  ds_read_b64_tr_b16 v[178:179], v246 offset:256
  s_waitcnt lgkmcnt(6)
  v_mfma_f32_32x32x16_bf16 v[16:31], v[180:183], v[100:103], v[16:31]
  ds_read_b64_tr_b16 v[180:181], v246 offset:512
  ds_read_b64_tr_b16 v[182:183], v246 offset:768
  s_waitcnt lgkmcnt(6)
  v_mfma_f32_32x32x16_bf16 v[16:31], v[184:187], v[104:107], v[16:31]
  ds_read_b64_tr_b16 v[184:185], v246 offset:1024
  ds_read_b64_tr_b16 v[186:187], v246 offset:1280
  s_waitcnt lgkmcnt(6)
  v_mfma_f32_32x32x16_bf16 v[16:31], v[188:191], v[108:111], v[16:31]
  ds_read_b64_tr_b16 v[188:189], v246 offset:1536
  ds_read_b64_tr_b16 v[190:191], v246 offset:1792
  s_waitcnt lgkmcnt(6)
  v_mfma_f32_32x32x16_bf16 v[16:31], v[176:179], v[112:115], v[16:31]
  s_lshl_b32 s64, s59, 12
  v_add_u32 v242, s64, v234
  s_add_u32 s59, s59, 1
  s_cmp_eq_u32 s59, 7
  s_cselect_b32 s59, 0, s59
  ds_read_b64_tr_b16 v[176:177], v242 offset:0
  ds_read_b64_tr_b16 v[178:179], v242 offset:256
  s_waitcnt lgkmcnt(6)
  v_mfma_f32_32x32x16_bf16 v[16:31], v[180:183], v[116:119], v[16:31]
  ds_read_b64_tr_b16 v[180:181], v242 offset:512
  ds_read_b64_tr_b16 v[182:183], v242 offset:768
  s_waitcnt lgkmcnt(6)
  v_mfma_f32_32x32x16_bf16 v[16:31], v[184:187], v[120:123], v[16:31]
  ds_read_b64_tr_b16 v[184:185], v242 offset:1024
  ds_read_b64_tr_b16 v[186:187], v242 offset:1280
  s_waitcnt lgkmcnt(6)
  v_mfma_f32_32x32x16_bf16 v[16:31], v[188:191], v[124:127], v[16:31]
  ds_read_b64_tr_b16 v[188:189], v242 offset:1536
  ds_read_b64_tr_b16 v[190:191], v242 offset:1792
  s_waitcnt lgkmcnt(6)
  v_mfma_f32_32x32x16_bf16 v[16:31], v[176:179], v[128:131], v[16:31]
  s_lshl_b32 s64, s59, 12
  v_add_u32 v246, s64, v234
  s_add_u32 s59, s59, 1
  s_cmp_eq_u32 s59, 7
  s_cselect_b32 s59, 0, s59
  ds_read_b64_tr_b16 v[176:177], v246 offset:0
  ds_read_b64_tr_b16 v[178:179], v246 offset:256
  s_waitcnt lgkmcnt(6)
  v_mfma_f32_32x32x16_bf16 v[16:31], v[180:183], v[132:135], v[16:31]
  ds_read_b64_tr_b16 v[180:181], v246 offset:512
  ds_read_b64_tr_b16 v[182:183], v246 offset:768
  s_waitcnt lgkmcnt(6)
  v_mfma_f32_32x32x16_bf16 v[16:31], v[184:187], v[136:139], v[16:31]
  ds_read_b64_tr_b16 v[184:185], v246 offset:1024
  ds_read_b64_tr_b16 v[186:187], v246 offset:1280
  s_waitcnt lgkmcnt(6)
  v_mfma_f32_32x32x16_bf16 v[16:31], v[188:191], v[140:143], v[16:31]
  ds_read_b64_tr_b16 v[188:189], v246 offset:1536
  ds_read_b64_tr_b16 v[190:191], v246 offset:1792
  s_waitcnt lgkmcnt(6)
  v_mfma_f32_32x32x16_bf16 v[16:31], v[176:179], v[144:147], v[16:31]
  s_lshl_b32 s64, s59, 12
  v_add_u32 v242, s64, v234
  s_add_u32 s59, s59, 1
  s_cmp_eq_u32 s59, 7
  s_cselect_b32 s59, 0, s59
  ds_read_b64_tr_b16 v[176:177], v242 offset:0
  ds_read_b64_tr_b16 v[178:179], v242 offset:256
  s_waitcnt lgkmcnt(6)
  v_mfma_f32_32x32x16_bf16 v[16:31], v[180:183], v[148:151], v[16:31]
  ds_read_b64_tr_b16 v[180:181], v242 offset:512
  ds_read_b64_tr_b16 v[182:183], v242 offset:768
  s_waitcnt lgkmcnt(6)
  v_mfma_f32_32x32x16_bf16 v[16:31], v[184:187], v[152:155], v[16:31]
  ds_read_b64_tr_b16 v[184:185], v242 offset:1024
  ds_read_b64_tr_b16 v[186:187], v242 offset:1280
  s_waitcnt lgkmcnt(6)
  v_mfma_f32_32x32x16_bf16 v[16:31], v[188:191], v[156:159], v[16:31]
  ds_read_b64_tr_b16 v[188:189], v242 offset:1536
  ds_read_b64_tr_b16 v[190:191], v242 offset:1792
  s_waitcnt lgkmcnt(6)
  v_mfma_f32_32x32x16_bf16 v[16:31], v[176:179], v[160:163], v[16:31]
  s_waitcnt lgkmcnt(4)
  v_mfma_f32_32x32x16_bf16 v[16:31], v[180:183], v[164:167], v[16:31]
  s_waitcnt lgkmcnt(2)
  v_mfma_f32_32x32x16_bf16 v[16:31], v[184:187], v[168:171], v[16:31]
  s_waitcnt lgkmcnt(0)
  v_mfma_f32_32x32x16_bf16 v[16:31], v[188:191], v[172:175], v[16:31]
  s_mov_b32 s64, 0x3e8b97f6
  v_mov_b32 v6, v244
  v_mov_b32 v7, v245
  v_add_u32 v3, 65536, v244
  v_mov_b32 v4, v244
  v_mov_b32 v5, v245
  v_mov_b32 v9, v248
  v_mov_b32 v10, v249
  v_mov_b32 v11, v251
  s_nop 2
  v_mov_b32 v12, v28
  v_mov_b32 v250, v28
  v_mul_f32 v16, s64, v16
  v_mul_f32 v17, s64, v17
  v_mul_f32 v18, s64, v18
  v_mul_f32 v19, s64, v19
  v_mul_f32 v20, s64, v20
  v_mul_f32 v21, s64, v21
  v_mul_f32 v22, s64, v22
  v_mul_f32 v23, s64, v23
  v_mul_f32 v24, s64, v24
  v_mul_f32 v25, s64, v25
  v_mul_f32 v26, s64, v26
  v_mul_f32 v27, s64, v27
  v_permlane32_swap_b32 v12, v250
  v_cvt_pk_bf16_f32 v220, v16, v17
  v_cvt_pk_bf16_f32 v221, v18, v19
  v_cvt_pk_bf16_f32 v222, v20, v21
  v_cvt_pk_bf16_f32 v223, v22, v23
  v_cvt_pk_bf16_f32 v224, v24, v25
  v_cvt_pk_bf16_f32 v225, v26, v27
  v_mov_b32 v226, 0
  v_mov_b32 v227, 0
  s_mov_b32 exec_hi, 0
  v_mul_f32 v28, s64, v28
  v_mul_f32 v29, s64, v29
  v_mul_f32 v30, s64, v30
  v_mul_f32 v31, s64, v31
  v_cvt_pk_bf16_f32 v226, v28, v29
  v_cvt_pk_bf16_f32 v227, v30, v31
  s_mov_b64 exec, -1
  v_mul_f32 v250, s60, v250
  v_exp_f32 v250, v250
  v_mfma_f32_32x32x16_bf16 v[96:111], v[200:203], v[220:223], 0
  v_mfma_f32_32x32x16_bf16 v[96:111], v[204:207], v[224:227], v[96:111]
  v_add_f32 v250, 1.0, v250
  v_rcp_f32 v250, v250
  ds_write_b128 v218, v[220:223]
  s_nop 8
  v_max3_f32 v12, v96, v97, v98
  v_max3_f32 v13, v99, v100, v101
  v_max3_f32 v12, v12, v102, v103
  v_max3_f32 v13, v13, v104, v105
  v_max3_f32 v12, v12, v106, v107
  v_max3_f32 v13, v13, v108, v109
  v_max3_f32 v12, v12, v110, v111
  v_max_f32 v12, v12, v13
  v_mov_b32 v13, v12
  s_nop 1
  v_permlane32_swap_b32 v12, v13
  s_nop 0
  v_max_f32 v12, v12, v13
  v_sub_f32 v12, 0, v12
  v_cvt_pk_bf16_f32 v13, v12, v12
  v_and_b32 v13, 0xffff0000, v13
  v_sub_f32 v14, v12, v13
  v_cvt_pk_bf16_f32 v15, v14, v14
  v_and_b32 v15, 0xffff0000, v15
  v_sub_f32 v14, v14, v15
  v_mov_b32 v12, 0
  s_mov_b64 exec, s[62:63]
  v_cvt_pk_bf16_f32 v226, v13, v15
  v_cvt_pk_bf16_f32 v227, v14, v12
  s_mov_b64 exec, -1
  ds_write_b128 v218, v[224:227] offset:1024
  s_waitcnt vmcnt(0) lgkmcnt(0)
  s_barrier
  s_cmp_lg_u32 s6, 0
  s_cbranch_scc1 L_noflag1
  s_lshl_b32 s66, s3, 7
  s_lshl_b32 s67, s5, 3
  s_add_u32 s66, s66, s67
  s_add_u32 s66, s66, 12591104
  v_mov_b32 v236, s56
  v_mov_b32 v237, s57
  s_mov_b64 exec, 1
  buffer_store_dwordx2 v[236:237], v235, s[36:39], s66 offen sc1
  s_mov_b64 exec, -1
L_noflag1:
  ds_read_b128 v[16:19], v9
  ds_read_b128 v[20:23], v9 offset:1024
  ds_read_b128 v[104:107], v3
  ds_read_b128 v[108:111], v3 offset:1024
  ds_read_b128 v[24:27], v9 offset:2048
  ds_read_b128 v[28:31], v9 offset:3072
  s_waitcnt lgkmcnt(2)
  v_mfma_f32_32x32x16_bf16 v[64:79], v[104:107], v[16:19], 0
  v_mfma_f32_32x32x16_bf16 v[64:79], v[108:111], v[20:23], v[64:79]
  s_waitcnt lgkmcnt(0)
  s_nop 10
  s_mov_b32 s67, 0
  s_nop 0
  ds_read_b128 v[112:115], v3 offset:4096
  v_exp_f32 v64, v64
  v_exp_f32 v65, v65
  ds_read_b128 v[116:119], v3 offset:5120
  v_exp_f32 v66, v66
  v_cvt_pk_bf16_f32 v96, v64, v65
  ds_read_b128 v[120:123], v3 offset:2048
  v_exp_f32 v67, v67
  v_exp_f32 v68, v68
  v_mfma_f32_32x32x16_bf16 v[80:95], v[104:107], v[24:27], 0
  ds_read_b128 v[124:127], v3 offset:3072
  v_cvt_pk_bf16_f32 v97, v66, v67
  v_exp_f32 v69, v69
  v_exp_f32 v70, v70
  v_exp_f32 v71, v71
  v_cvt_pk_bf16_f32 v98, v68, v69
  v_exp_f32 v72, v72
  v_mfma_f32_32x32x16_bf16 v[80:95], v[108:111], v[28:31], v[80:95]
  v_exp_f32 v73, v73
  v_cvt_pk_bf16_f32 v99, v70, v71
  v_exp_f32 v74, v74
  v_exp_f32 v75, v75
  v_exp_f32 v76, v76
  s_nop 0
  v_exp_f32 v77, v77
  v_cvt_pk_bf16_f32 v100, v72, v73
  v_exp_f32 v78, v78
  v_cvt_pk_bf16_f32 v101, v74, v75
  v_exp_f32 v79, v79
  v_cvt_pk_bf16_f32 v102, v76, v77
  v_cvt_pk_bf16_f32 v103, v78, v79
  s_waitcnt lgkmcnt(0)
  v_mfma_f32_32x32x16_bf16 v[32:47], v[120:123], v[96:99], 0
  v_exp_f32 v80, v80
  v_exp_f32 v81, v81
  v_exp_f32 v82, v82
  v_cvt_pk_bf16_f32 v96, v80, v81
  v_exp_f32 v83, v83
  v_exp_f32 v84, v84
  v_mfma_f32_32x32x16_bf16 v[64:79], v[112:115], v[16:19], 0
  v_cvt_pk_bf16_f32 v97, v82, v83
  v_exp_f32 v85, v85
  v_exp_f32 v86, v86
  v_exp_f32 v87, v87
  v_cvt_pk_bf16_f32 v98, v84, v85
  v_exp_f32 v88, v88
  v_mfma_f32_32x32x16_bf16 v[64:79], v[116:119], v[20:23], v[64:79]
  v_exp_f32 v89, v89
  v_cvt_pk_bf16_f32 v99, v86, v87
  v_exp_f32 v90, v90
  v_exp_f32 v91, v91
  v_exp_f32 v92, v92
  v_mfma_f32_32x32x16_bf16 v[32:47], v[124:127], v[100:103], v[32:47]
  v_exp_f32 v93, v93
  v_cvt_pk_bf16_f32 v100, v88, v89
  v_exp_f32 v94, v94
  v_cvt_pk_bf16_f32 v101, v90, v91
  v_exp_f32 v95, v95
  v_cvt_pk_bf16_f32 v102, v92, v93
  v_cvt_pk_bf16_f32 v103, v94, v95
  v_mfma_f32_32x32x16_bf16 v[48:63], v[120:123], v[96:99], 0
  ds_read_b128 v[104:107], v3 offset:8192
  v_exp_f32 v64, v64
  v_exp_f32 v65, v65
  ds_read_b128 v[108:111], v3 offset:9216
  v_exp_f32 v66, v66
  v_cvt_pk_bf16_f32 v96, v64, v65
  ds_read_b128 v[128:131], v3 offset:6144
  v_exp_f32 v67, v67
  v_exp_f32 v68, v68
  v_mfma_f32_32x32x16_bf16 v[80:95], v[112:115], v[24:27], 0
  ds_read_b128 v[132:135], v3 offset:7168
  v_cvt_pk_bf16_f32 v97, v66, v67
  v_exp_f32 v69, v69
  v_exp_f32 v70, v70
  v_exp_f32 v71, v71
  v_cvt_pk_bf16_f32 v98, v68, v69
  v_exp_f32 v72, v72
  v_mfma_f32_32x32x16_bf16 v[80:95], v[116:119], v[28:31], v[80:95]
  v_exp_f32 v73, v73
  v_cvt_pk_bf16_f32 v99, v70, v71
  v_exp_f32 v74, v74
  v_exp_f32 v75, v75
  v_exp_f32 v76, v76
  v_mfma_f32_32x32x16_bf16 v[48:63], v[124:127], v[100:103], v[48:63]
  v_exp_f32 v77, v77
  v_cvt_pk_bf16_f32 v100, v72, v73
  v_exp_f32 v78, v78
  v_cvt_pk_bf16_f32 v101, v74, v75
  v_exp_f32 v79, v79
  v_cvt_pk_bf16_f32 v102, v76, v77
  v_cvt_pk_bf16_f32 v103, v78, v79
  s_waitcnt lgkmcnt(0)
  v_mfma_f32_32x32x16_bf16 v[32:47], v[128:131], v[96:99], v[32:47]
  v_exp_f32 v80, v80
  v_exp_f32 v81, v81
  v_exp_f32 v82, v82
  v_cvt_pk_bf16_f32 v96, v80, v81
  v_exp_f32 v83, v83
  v_exp_f32 v84, v84
  v_mfma_f32_32x32x16_bf16 v[64:79], v[104:107], v[16:19], 0
  v_cvt_pk_bf16_f32 v97, v82, v83
  v_exp_f32 v85, v85
  v_exp_f32 v86, v86
  v_exp_f32 v87, v87
  v_cvt_pk_bf16_f32 v98, v84, v85
  v_exp_f32 v88, v88
  v_mfma_f32_32x32x16_bf16 v[64:79], v[108:111], v[20:23], v[64:79]
  v_exp_f32 v89, v89
  v_cvt_pk_bf16_f32 v99, v86, v87
  v_exp_f32 v90, v90
  v_exp_f32 v91, v91
  v_exp_f32 v92, v92
  v_mfma_f32_32x32x16_bf16 v[32:47], v[132:135], v[100:103], v[32:47]
  v_exp_f32 v93, v93
  v_cvt_pk_bf16_f32 v100, v88, v89
  v_exp_f32 v94, v94
  v_cvt_pk_bf16_f32 v101, v90, v91
  v_exp_f32 v95, v95
  v_cvt_pk_bf16_f32 v102, v92, v93
  v_cvt_pk_bf16_f32 v103, v94, v95
  s_cmp_lg_u32 s6, 0
  s_cbranch_scc1 L_p1_done
  s_mov_b32 s58, 0
L_p1:
  buffer_load_dwordx2 v[152:153], v10, s[36:39], s97 offen sc1
  s_waitcnt vmcnt(0)
  v_cmp_eq_u64 vcc, s[56:57], v[152:153]
  s_add_u32 s58, s58, 1
  s_cmp_ge_u32 s58, 262144
  s_cbranch_scc1 L_p1_done
  s_cmp_eq_u64 vcc, exec
  s_cbranch_scc1 L_p1_done
  s_sleep 1
  s_branch L_p1
L_p1_done:
  s_barrier
  s_and_b32 s53, s99, 7
  s_lshl_b32 s53, s53, 15
  s_add_u32 s53, s53, s98
  s_add_u32 s99, s99, 1
  s_add_u32 s68, s67, s40
  s_mov_b32 m0, s68
  s_nop 0
  buffer_load_dwordx4 v2, s[36:39], s53 offen offset:0 sc1 lds
  v_mfma_f32_32x32x16_bf16 v[48:63], v[128:131], v[96:99], v[48:63]
  ds_read_b128 v[112:115], v3 offset:12288
  v_exp_f32 v64, v64
  v_exp_f32 v65, v65
  ds_read_b128 v[116:119], v3 offset:13312
  v_exp_f32 v66, v66
  v_cvt_pk_bf16_f32 v96, v64, v65
  ds_read_b128 v[120:123], v3 offset:10240
  v_exp_f32 v67, v67
  v_exp_f32 v68, v68
  v_mfma_f32_32x32x16_bf16 v[80:95], v[104:107], v[24:27], 0
  s_mov_b32 m0, s68
  s_nop 0
  buffer_load_dwordx4 v2, s[36:39], s53 offen offset:1024 sc1 lds
  ds_read_b128 v[124:127], v3 offset:11264
  v_cvt_pk_bf16_f32 v97, v66, v67
  v_exp_f32 v69, v69
  v_exp_f32 v70, v70
  v_exp_f32 v71, v71
  v_cvt_pk_bf16_f32 v98, v68, v69
  v_exp_f32 v72, v72
  v_mfma_f32_32x32x16_bf16 v[80:95], v[108:111], v[28:31], v[80:95]
  v_exp_f32 v73, v73
  s_mov_b32 m0, s68
  s_nop 0
  buffer_load_dwordx4 v2, s[36:39], s53 offen offset:2048 sc1 lds
  v_cvt_pk_bf16_f32 v99, v70, v71
  v_exp_f32 v74, v74
  v_exp_f32 v75, v75
  v_exp_f32 v76, v76
  v_mfma_f32_32x32x16_bf16 v[48:63], v[132:135], v[100:103], v[48:63]
  v_exp_f32 v77, v77
  v_cvt_pk_bf16_f32 v100, v72, v73
  v_exp_f32 v78, v78
  s_mov_b32 m0, s68
  s_nop 0
  buffer_load_dwordx4 v2, s[36:39], s53 offen offset:3072 sc1 lds
  s_add_u32 s67, s67, 32768
  s_cmp_eq_u32 s67, 98304
  s_cselect_b32 s67, 0, s67
  v_cvt_pk_bf16_f32 v101, v74, v75
  v_exp_f32 v79, v79
  v_cvt_pk_bf16_f32 v102, v76, v77
  v_cvt_pk_bf16_f32 v103, v78, v79
  s_waitcnt lgkmcnt(0)
  v_mfma_f32_32x32x16_bf16 v[32:47], v[120:123], v[96:99], v[32:47]
  v_exp_f32 v80, v80
  v_exp_f32 v81, v81
  v_exp_f32 v82, v82
  v_cvt_pk_bf16_f32 v96, v80, v81
  v_exp_f32 v83, v83
  v_exp_f32 v84, v84
  v_mfma_f32_32x32x16_bf16 v[64:79], v[112:115], v[16:19], 0
  v_cvt_pk_bf16_f32 v97, v82, v83
  v_exp_f32 v85, v85
  v_exp_f32 v86, v86
  v_exp_f32 v87, v87
  v_cvt_pk_bf16_f32 v98, v84, v85
  v_exp_f32 v88, v88
  v_mfma_f32_32x32x16_bf16 v[64:79], v[116:119], v[20:23], v[64:79]
  v_exp_f32 v89, v89
  v_cvt_pk_bf16_f32 v99, v86, v87
  v_exp_f32 v90, v90
  v_exp_f32 v91, v91
  v_exp_f32 v92, v92
  v_mfma_f32_32x32x16_bf16 v[32:47], v[124:127], v[100:103], v[32:47]
  v_exp_f32 v93, v93
  v_cvt_pk_bf16_f32 v100, v88, v89
  v_exp_f32 v94, v94
  v_cvt_pk_bf16_f32 v101, v90, v91
  v_exp_f32 v95, v95
  v_cvt_pk_bf16_f32 v102, v92, v93
  v_cvt_pk_bf16_f32 v103, v94, v95
  v_mfma_f32_32x32x16_bf16 v[48:63], v[120:123], v[96:99], v[48:63]
  v_exp_f32 v64, v64
  v_exp_f32 v65, v65
  v_exp_f32 v66, v66
  v_cvt_pk_bf16_f32 v96, v64, v65
  ds_read_b128 v[128:131], v3 offset:14336
  v_exp_f32 v67, v67
  v_exp_f32 v68, v68
  v_mfma_f32_32x32x16_bf16 v[80:95], v[112:115], v[24:27], 0
  ds_read_b128 v[132:135], v3 offset:15360
  v_cvt_pk_bf16_f32 v97, v66, v67
  v_exp_f32 v69, v69
  v_exp_f32 v70, v70
  v_exp_f32 v71, v71
  v_cvt_pk_bf16_f32 v98, v68, v69
  v_exp_f32 v72, v72
  v_mfma_f32_32x32x16_bf16 v[80:95], v[116:119], v[28:31], v[80:95]
  v_exp_f32 v73, v73
  v_cvt_pk_bf16_f32 v99, v70, v71
  v_exp_f32 v74, v74
  v_exp_f32 v75, v75
  v_exp_f32 v76, v76
  v_mfma_f32_32x32x16_bf16 v[48:63], v[124:127], v[100:103], v[48:63]
  v_exp_f32 v77, v77
  v_cvt_pk_bf16_f32 v100, v72, v73
  v_exp_f32 v78, v78
  v_cvt_pk_bf16_f32 v101, v74, v75
  v_exp_f32 v79, v79
  v_cvt_pk_bf16_f32 v102, v76, v77
  v_cvt_pk_bf16_f32 v103, v78, v79
  s_waitcnt vmcnt(0) lgkmcnt(0)
  s_barrier
  ds_read_b128 v[104:107], v4
  ds_read_b128 v[108:111], v4 offset:1024
  v_mfma_f32_32x32x16_bf16 v[32:47], v[128:131], v[96:99], v[32:47]
  v_exp_f32 v80, v80
  s_and_b32 s53, s99, 7
  s_lshl_b32 s53, s53, 15
  s_add_u32 s53, s53, s98
  s_add_u32 s99, s99, 1
  s_add_u32 s68, s67, s40
  s_mov_b32 m0, s68
  s_nop 0
  buffer_load_dwordx4 v2, s[36:39], s53 offen offset:0 sc1 lds
  v_exp_f32 v81, v81
  v_exp_f32 v82, v82
  v_cvt_pk_bf16_f32 v96, v80, v81
  v_exp_f32 v83, v83
  v_exp_f32 v84, v84
  s_waitcnt lgkmcnt(0)
  v_mfma_f32_32x32x16_bf16 v[64:79], v[104:107], v[16:19], 0
  v_cvt_pk_bf16_f32 v97, v82, v83
  s_mov_b32 m0, s68
  s_nop 0
  buffer_load_dwordx4 v2, s[36:39], s53 offen offset:1024 sc1 lds
  v_exp_f32 v85, v85
  v_exp_f32 v86, v86
  v_exp_f32 v87, v87
  v_cvt_pk_bf16_f32 v98, v84, v85
  v_exp_f32 v88, v88
  v_mfma_f32_32x32x16_bf16 v[64:79], v[108:111], v[20:23], v[64:79]
  s_mov_b32 m0, s68
  s_nop 0
  buffer_load_dwordx4 v2, s[36:39], s53 offen offset:2048 sc1 lds
  v_exp_f32 v89, v89
  v_cvt_pk_bf16_f32 v99, v86, v87
  v_exp_f32 v90, v90
  v_exp_f32 v91, v91
  v_exp_f32 v92, v92
  v_mov_b32 v3, v4
  s_add_u32 s49, s49, 32768
  s_cmp_eq_u32 s49, 98304
  s_cselect_b32 s49, 0, s49
  v_mfma_f32_32x32x16_bf16 v[32:47], v[132:135], v[100:103], v[32:47]
  s_mov_b32 m0, s68
  s_nop 0
  buffer_load_dwordx4 v2, s[36:39], s53 offen offset:3072 sc1 lds
  s_add_u32 s67, s67, 32768
  s_cmp_eq_u32 s67, 98304
  s_cselect_b32 s67, 0, s67
  v_exp_f32 v93, v93
  v_add_u32 v4, s49, v6
  v_cvt_pk_bf16_f32 v100, v88, v89
  v_exp_f32 v94, v94
  v_cvt_pk_bf16_f32 v101, v90, v91
  v_exp_f32 v95, v95
  v_cvt_pk_bf16_f32 v102, v92, v93
  v_cvt_pk_bf16_f32 v103, v94, v95
  v_mfma_f32_32x32x16_bf16 v[48:63], v[128:131], v[96:99], v[48:63]
  ds_read_b128 v[112:115], v3 offset:4096
  v_exp_f32 v64, v64
  v_exp_f32 v65, v65
  ds_read_b128 v[116:119], v3 offset:5120
  v_exp_f32 v66, v66
  v_cvt_pk_bf16_f32 v96, v64, v65
  ds_read_b128 v[120:123], v3 offset:2048
  v_exp_f32 v67, v67
  v_exp_f32 v68, v68
  v_mfma_f32_32x32x16_bf16 v[80:95], v[104:107], v[24:27], 0
  ds_read_b128 v[124:127], v3 offset:3072
  v_cvt_pk_bf16_f32 v97, v66, v67
  v_exp_f32 v69, v69
  v_exp_f32 v70, v70
  v_exp_f32 v71, v71
  s_mov_b32 m0, s43
  s_add_u32 s43, s43, 8192
  buffer_load_dwordx4 v11, s[44:47], s101 offen lds
  s_add_u32 s101, s101, 57344
  v_cvt_pk_bf16_f32 v98, v68, v69
  v_exp_f32 v72, v72
  v_mfma_f32_32x32x16_bf16 v[80:95], v[108:111], v[28:31], v[80:95]
  v_exp_f32 v73, v73
  v_cvt_pk_bf16_f32 v99, v70, v71
  v_exp_f32 v74, v74
  v_exp_f32 v75, v75
  v_exp_f32 v76, v76
  v_mfma_f32_32x32x16_bf16 v[48:63], v[132:135], v[100:103], v[48:63]
  v_exp_f32 v77, v77
  v_cvt_pk_bf16_f32 v100, v72, v73
  v_exp_f32 v78, v78
  v_cvt_pk_bf16_f32 v101, v74, v75
  v_exp_f32 v79, v79
  v_cvt_pk_bf16_f32 v102, v76, v77
  v_cvt_pk_bf16_f32 v103, v78, v79
  s_waitcnt lgkmcnt(0)
  v_mfma_f32_32x32x16_bf16 v[32:47], v[120:123], v[96:99], v[32:47]
  v_exp_f32 v80, v80
  v_exp_f32 v81, v81
  v_exp_f32 v82, v82
  v_cvt_pk_bf16_f32 v96, v80, v81
  v_exp_f32 v83, v83
  v_exp_f32 v84, v84
  v_mfma_f32_32x32x16_bf16 v[64:79], v[112:115], v[16:19], 0
  v_cvt_pk_bf16_f32 v97, v82, v83
  v_exp_f32 v85, v85
  v_exp_f32 v86, v86
  v_exp_f32 v87, v87
  s_mov_b32 m0, s43
  s_add_u32 s43, s43, 8192
  buffer_load_dwordx4 v11, s[44:47], s101 offen lds
  s_add_u32 s101, s101, 57344
  v_cvt_pk_bf16_f32 v98, v84, v85
  v_exp_f32 v88, v88
  v_mfma_f32_32x32x16_bf16 v[64:79], v[116:119], v[20:23], v[64:79]
  v_exp_f32 v89, v89
  v_cvt_pk_bf16_f32 v99, v86, v87
  v_exp_f32 v90, v90
  v_exp_f32 v91, v91
  v_exp_f32 v92, v92
  v_mfma_f32_32x32x16_bf16 v[32:47], v[124:127], v[100:103], v[32:47]
  v_exp_f32 v93, v93
  v_cvt_pk_bf16_f32 v100, v88, v89
  v_exp_f32 v94, v94
  v_cvt_pk_bf16_f32 v101, v90, v91
  v_exp_f32 v95, v95
  v_cvt_pk_bf16_f32 v102, v92, v93
  v_cvt_pk_bf16_f32 v103, v94, v95
  v_mfma_f32_32x32x16_bf16 v[48:63], v[120:123], v[96:99], v[48:63]
  ds_read_b128 v[104:107], v3 offset:8192
  v_exp_f32 v64, v64
  v_exp_f32 v65, v65
  ds_read_b128 v[108:111], v3 offset:9216
  v_exp_f32 v66, v66
  v_cvt_pk_bf16_f32 v96, v64, v65
  ds_read_b128 v[128:131], v3 offset:6144
  v_exp_f32 v67, v67
  v_exp_f32 v68, v68
  v_mfma_f32_32x32x16_bf16 v[80:95], v[112:115], v[24:27], 0
  ds_read_b128 v[132:135], v3 offset:7168
  v_cvt_pk_bf16_f32 v97, v66, v67
  v_exp_f32 v69, v69
  v_exp_f32 v70, v70
  v_exp_f32 v71, v71
  s_mov_b32 m0, s43
  s_add_u32 s43, s43, 8192
  buffer_load_dwordx4 v11, s[44:47], s101 offen lds
  s_add_u32 s101, s101, 57344
  v_cvt_pk_bf16_f32 v98, v68, v69
  v_exp_f32 v72, v72
  v_mfma_f32_32x32x16_bf16 v[80:95], v[116:119], v[28:31], v[80:95]
  v_exp_f32 v73, v73
  v_cvt_pk_bf16_f32 v99, v70, v71
  v_exp_f32 v74, v74
  v_exp_f32 v75, v75
  v_exp_f32 v76, v76
  v_mfma_f32_32x32x16_bf16 v[48:63], v[124:127], v[100:103], v[48:63]
  v_exp_f32 v77, v77
  v_cvt_pk_bf16_f32 v100, v72, v73
  v_exp_f32 v78, v78
  v_cvt_pk_bf16_f32 v101, v74, v75
  v_exp_f32 v79, v79
  v_cvt_pk_bf16_f32 v102, v76, v77
  v_cvt_pk_bf16_f32 v103, v78, v79
  s_waitcnt lgkmcnt(0)
  v_mfma_f32_32x32x16_bf16 v[32:47], v[128:131], v[96:99], v[32:47]
  v_exp_f32 v80, v80
  v_exp_f32 v81, v81
  v_exp_f32 v82, v82
  v_cvt_pk_bf16_f32 v96, v80, v81
  v_exp_f32 v83, v83
  v_exp_f32 v84, v84
  v_mfma_f32_32x32x16_bf16 v[64:79], v[104:107], v[16:19], 0
  v_cvt_pk_bf16_f32 v97, v82, v83
  v_exp_f32 v85, v85
  v_exp_f32 v86, v86
  v_exp_f32 v87, v87
  s_mov_b32 m0, s43
  s_add_u32 s43, s43, 8192
  buffer_load_dwordx4 v11, s[44:47], s101 offen lds
  s_add_u32 s101, s101, 57344
  v_cvt_pk_bf16_f32 v98, v84, v85
  v_exp_f32 v88, v88
  v_mfma_f32_32x32x16_bf16 v[64:79], v[108:111], v[20:23], v[64:79]
  v_exp_f32 v89, v89
  v_cvt_pk_bf16_f32 v99, v86, v87
  v_exp_f32 v90, v90
  v_exp_f32 v91, v91
  v_exp_f32 v92, v92
  v_mfma_f32_32x32x16_bf16 v[32:47], v[132:135], v[100:103], v[32:47]
  v_exp_f32 v93, v93
  v_cvt_pk_bf16_f32 v100, v88, v89
  v_exp_f32 v94, v94
  v_cvt_pk_bf16_f32 v101, v90, v91
  v_exp_f32 v95, v95
  v_cvt_pk_bf16_f32 v102, v92, v93
  v_cvt_pk_bf16_f32 v103, v94, v95
  v_mfma_f32_32x32x16_bf16 v[48:63], v[128:131], v[96:99], v[48:63]
  ds_read_b128 v[112:115], v3 offset:12288
  v_exp_f32 v64, v64
  v_exp_f32 v65, v65
  ds_read_b128 v[116:119], v3 offset:13312
  v_exp_f32 v66, v66
  v_cvt_pk_bf16_f32 v96, v64, v65
  ds_read_b128 v[120:123], v3 offset:10240
  v_exp_f32 v67, v67
  v_exp_f32 v68, v68
  v_mfma_f32_32x32x16_bf16 v[80:95], v[104:107], v[24:27], 0
  ds_read_b128 v[124:127], v3 offset:11264
  v_cvt_pk_bf16_f32 v97, v66, v67
  v_exp_f32 v69, v69
  v_exp_f32 v70, v70
  v_exp_f32 v71, v71
  v_cvt_pk_bf16_f32 v98, v68, v69
  v_exp_f32 v72, v72
  v_mfma_f32_32x32x16_bf16 v[80:95], v[108:111], v[28:31], v[80:95]
  v_exp_f32 v73, v73
  v_cvt_pk_bf16_f32 v99, v70, v71
  v_exp_f32 v74, v74
  v_exp_f32 v75, v75
  v_exp_f32 v76, v76
  v_mfma_f32_32x32x16_bf16 v[48:63], v[132:135], v[100:103], v[48:63]
  v_exp_f32 v77, v77
  v_cvt_pk_bf16_f32 v100, v72, v73
  v_exp_f32 v78, v78
  v_cvt_pk_bf16_f32 v101, v74, v75
  v_exp_f32 v79, v79
  v_cvt_pk_bf16_f32 v102, v76, v77
  v_cvt_pk_bf16_f32 v103, v78, v79
  s_waitcnt lgkmcnt(0)
  v_mfma_f32_32x32x16_bf16 v[32:47], v[120:123], v[96:99], v[32:47]
  v_exp_f32 v80, v80
  v_exp_f32 v81, v81
  v_exp_f32 v82, v82
  v_cvt_pk_bf16_f32 v96, v80, v81
  v_exp_f32 v83, v83
  v_exp_f32 v84, v84
  v_mfma_f32_32x32x16_bf16 v[64:79], v[112:115], v[16:19], 0
  v_cvt_pk_bf16_f32 v97, v82, v83
  v_exp_f32 v85, v85
  v_exp_f32 v86, v86
  v_exp_f32 v87, v87
  v_cvt_pk_bf16_f32 v98, v84, v85
  v_exp_f32 v88, v88
  v_mfma_f32_32x32x16_bf16 v[64:79], v[116:119], v[20:23], v[64:79]
  v_exp_f32 v89, v89
  v_cvt_pk_bf16_f32 v99, v86, v87
  v_exp_f32 v90, v90
  v_exp_f32 v91, v91
  v_exp_f32 v92, v92
  v_mfma_f32_32x32x16_bf16 v[32:47], v[124:127], v[100:103], v[32:47]
  v_exp_f32 v93, v93
  v_cvt_pk_bf16_f32 v100, v88, v89
  v_exp_f32 v94, v94
  v_cvt_pk_bf16_f32 v101, v90, v91
  v_exp_f32 v95, v95
  v_cvt_pk_bf16_f32 v102, v92, v93
  v_cvt_pk_bf16_f32 v103, v94, v95
  s_waitcnt vmcnt(4) lgkmcnt(0)
  s_barrier
  v_mfma_f32_32x32x16_bf16 v[48:63], v[120:123], v[96:99], v[48:63]
  ds_read_b128 v[104:107], v4
  v_exp_f32 v64, v64
  v_exp_f32 v65, v65
  ds_read_b128 v[108:111], v4 offset:1024
  v_exp_f32 v66, v66
  v_cvt_pk_bf16_f32 v96, v64, v65
  ds_read_b128 v[128:131], v3 offset:14336
  v_exp_f32 v67, v67
  v_exp_f32 v68, v68
  v_mfma_f32_32x32x16_bf16 v[80:95], v[112:115], v[24:27], 0
  ds_read_b128 v[132:135], v3 offset:15360
  v_cvt_pk_bf16_f32 v97, v66, v67
  v_exp_f32 v69, v69
  s_and_b32 s53, s99, 7
  s_lshl_b32 s53, s53, 15
  s_add_u32 s53, s53, s98
  s_add_u32 s99, s99, 1
  s_add_u32 s68, s67, s40
  s_mov_b32 m0, s68
  s_nop 0
  buffer_load_dwordx4 v2, s[36:39], s53 offen offset:0 sc1 lds
  v_exp_f32 v70, v70
  v_exp_f32 v71, v71
  v_cvt_pk_bf16_f32 v98, v68, v69
  v_exp_f32 v72, v72
  v_mfma_f32_32x32x16_bf16 v[80:95], v[116:119], v[28:31], v[80:95]
  v_exp_f32 v73, v73
  v_cvt_pk_bf16_f32 v99, v70, v71
  v_exp_f32 v74, v74
  v_exp_f32 v75, v75
  v_exp_f32 v76, v76
  v_mfma_f32_32x32x16_bf16 v[48:63], v[124:127], v[100:103], v[48:63]
  v_exp_f32 v77, v77
  v_cvt_pk_bf16_f32 v100, v72, v73
  v_exp_f32 v78, v78
  v_cvt_pk_bf16_f32 v101, v74, v75
  v_exp_f32 v79, v79
  v_cvt_pk_bf16_f32 v102, v76, v77
  v_cvt_pk_bf16_f32 v103, v78, v79
  s_waitcnt lgkmcnt(0)
  v_mfma_f32_32x32x16_bf16 v[32:47], v[128:131], v[96:99], v[32:47]
  v_exp_f32 v80, v80
  v_exp_f32 v81, v81
  v_exp_f32 v82, v82
  v_cvt_pk_bf16_f32 v96, v80, v81
  v_exp_f32 v83, v83
  v_exp_f32 v84, v84
  v_mfma_f32_32x32x16_bf16 v[64:79], v[104:107], v[16:19], 0
  v_cvt_pk_bf16_f32 v97, v82, v83
  v_exp_f32 v85, v85
  s_mov_b32 m0, s68
  s_nop 0
  buffer_load_dwordx4 v2, s[36:39], s53 offen offset:1024 sc1 lds
  v_exp_f32 v86, v86
  v_exp_f32 v87, v87
  v_cvt_pk_bf16_f32 v98, v84, v85
  v_exp_f32 v88, v88
  v_mfma_f32_32x32x16_bf16 v[64:79], v[108:111], v[20:23], v[64:79]
  v_exp_f32 v89, v89
  v_cvt_pk_bf16_f32 v99, v86, v87
  v_exp_f32 v90, v90
  v_exp_f32 v91, v91
  v_exp_f32 v92, v92
  v_mov_b32 v3, v4
  s_add_u32 s49, s49, 32768
  s_cmp_eq_u32 s49, 98304
  s_cselect_b32 s49, 0, s49
  v_mfma_f32_32x32x16_bf16 v[32:47], v[132:135], v[100:103], v[32:47]
  v_exp_f32 v93, v93
  v_add_u32 v4, s49, v6
  v_cvt_pk_bf16_f32 v100, v88, v89
  v_exp_f32 v94, v94
  v_cvt_pk_bf16_f32 v101, v90, v91
  v_exp_f32 v95, v95
  v_cvt_pk_bf16_f32 v102, v92, v93
  v_cvt_pk_bf16_f32 v103, v94, v95
  s_mov_b32 s48, 2
  .p2align 6
L_loop:
  v_mfma_f32_32x32x16_bf16 v[48:63], v[128:131], v[96:99], v[48:63]
  ds_read_b128 v[112:115], v3 offset:4096
  v_exp_f32 v64, v64
  v_exp_f32 v65, v65
  ds_read_b128 v[116:119], v3 offset:5120
  v_exp_f32 v66, v66
  v_cvt_pk_bf16_f32 v96, v64, v65
  ds_read_b128 v[120:123], v3 offset:2048
  v_exp_f32 v67, v67
  v_exp_f32 v68, v68
  v_mfma_f32_32x32x16_bf16 v[80:95], v[104:107], v[24:27], 0
  ds_read_b128 v[124:127], v3 offset:3072
  v_cvt_pk_bf16_f32 v97, v66, v67
  v_exp_f32 v69, v69
  v_exp_f32 v70, v70
  v_exp_f32 v71, v71
  v_cvt_pk_bf16_f32 v98, v68, v69
  v_exp_f32 v72, v72
  s_mov_b32 m0, s68
  s_nop 0
  buffer_load_dwordx4 v2, s[36:39], s53 offen offset:2048 sc1 lds
  v_mfma_f32_32x32x16_bf16 v[80:95], v[108:111], v[28:31], v[80:95]
  v_exp_f32 v73, v73
  v_cvt_pk_bf16_f32 v99, v70, v71
  v_exp_f32 v74, v74
  v_exp_f32 v75, v75
  v_exp_f32 v76, v76
  v_mfma_f32_32x32x16_bf16 v[48:63], v[132:135], v[100:103], v[48:63]
  v_exp_f32 v77, v77
  v_cvt_pk_bf16_f32 v100, v72, v73
  v_exp_f32 v78, v78
  v_cvt_pk_bf16_f32 v101, v74, v75
  v_exp_f32 v79, v79
  v_cvt_pk_bf16_f32 v102, v76, v77
  v_cvt_pk_bf16_f32 v103, v78, v79
  s_waitcnt lgkmcnt(0)
  v_mfma_f32_32x32x16_bf16 v[32:47], v[120:123], v[96:99], v[32:47]
  v_exp_f32 v80, v80
  v_exp_f32 v81, v81
  v_exp_f32 v82, v82
  v_cvt_pk_bf16_f32 v96, v80, v81
  v_exp_f32 v83, v83
  v_exp_f32 v84, v84
  v_mfma_f32_32x32x16_bf16 v[64:79], v[112:115], v[16:19], 0
  v_cvt_pk_bf16_f32 v97, v82, v83
  v_exp_f32 v85, v85
  v_exp_f32 v86, v86
  v_exp_f32 v87, v87
  v_cvt_pk_bf16_f32 v98, v84, v85
  v_exp_f32 v88, v88
  s_mov_b32 m0, s68
  s_nop 0
  buffer_load_dwordx4 v2, s[36:39], s53 offen offset:3072 sc1 lds
  s_add_u32 s67, s67, 32768
  s_cmp_eq_u32 s67, 98304
  s_cselect_b32 s67, 0, s67
  v_mfma_f32_32x32x16_bf16 v[64:79], v[116:119], v[20:23], v[64:79]
  v_exp_f32 v89, v89
  v_cvt_pk_bf16_f32 v99, v86, v87
  v_exp_f32 v90, v90
  v_exp_f32 v91, v91
  v_exp_f32 v92, v92
  v_mfma_f32_32x32x16_bf16 v[32:47], v[124:127], v[100:103], v[32:47]
  v_exp_f32 v93, v93
  v_cvt_pk_bf16_f32 v100, v88, v89
  v_exp_f32 v94, v94
  v_cvt_pk_bf16_f32 v101, v90, v91
  v_exp_f32 v95, v95
  v_cvt_pk_bf16_f32 v102, v92, v93
  v_cvt_pk_bf16_f32 v103, v94, v95
  v_mfma_f32_32x32x16_bf16 v[48:63], v[120:123], v[96:99], v[48:63]
  ds_read_b128 v[104:107], v3 offset:8192
  v_exp_f32 v64, v64
  v_exp_f32 v65, v65
  ds_read_b128 v[108:111], v3 offset:9216
  v_exp_f32 v66, v66
  v_cvt_pk_bf16_f32 v96, v64, v65
  ds_read_b128 v[128:131], v3 offset:6144
  v_exp_f32 v67, v67
  v_exp_f32 v68, v68
  v_mfma_f32_32x32x16_bf16 v[80:95], v[112:115], v[24:27], 0
  ds_read_b128 v[132:135], v3 offset:7168
  v_cvt_pk_bf16_f32 v97, v66, v67
  v_exp_f32 v69, v69
  v_exp_f32 v70, v70
  v_exp_f32 v71, v71
  v_cvt_pk_bf16_f32 v98, v68, v69
  v_exp_f32 v72, v72
  v_mfma_f32_32x32x16_bf16 v[80:95], v[116:119], v[28:31], v[80:95]
  v_exp_f32 v73, v73
  v_cvt_pk_bf16_f32 v99, v70, v71
  v_exp_f32 v74, v74
  v_exp_f32 v75, v75
  v_exp_f32 v76, v76
  v_mfma_f32_32x32x16_bf16 v[48:63], v[124:127], v[100:103], v[48:63]
  v_exp_f32 v77, v77
  v_cvt_pk_bf16_f32 v100, v72, v73
  v_exp_f32 v78, v78
  v_cvt_pk_bf16_f32 v101, v74, v75
  v_exp_f32 v79, v79
  v_cvt_pk_bf16_f32 v102, v76, v77
  v_cvt_pk_bf16_f32 v103, v78, v79
  s_waitcnt lgkmcnt(0)
  v_mfma_f32_32x32x16_bf16 v[32:47], v[128:131], v[96:99], v[32:47]
  v_exp_f32 v80, v80
  v_exp_f32 v81, v81
  v_exp_f32 v82, v82
  v_cvt_pk_bf16_f32 v96, v80, v81
  v_exp_f32 v83, v83
  v_exp_f32 v84, v84
  v_mfma_f32_32x32x16_bf16 v[64:79], v[104:107], v[16:19], 0
  v_cvt_pk_bf16_f32 v97, v82, v83
  v_exp_f32 v85, v85
  v_exp_f32 v86, v86
  v_exp_f32 v87, v87
  v_cvt_pk_bf16_f32 v98, v84, v85
  v_exp_f32 v88, v88
  v_mfma_f32_32x32x16_bf16 v[64:79], v[108:111], v[20:23], v[64:79]
  v_exp_f32 v89, v89
  v_cvt_pk_bf16_f32 v99, v86, v87
  v_exp_f32 v90, v90
  v_exp_f32 v91, v91
  v_exp_f32 v92, v92
  v_mfma_f32_32x32x16_bf16 v[32:47], v[132:135], v[100:103], v[32:47]
  v_exp_f32 v93, v93
  v_cvt_pk_bf16_f32 v100, v88, v89
  v_exp_f32 v94, v94
  v_cvt_pk_bf16_f32 v101, v90, v91
  v_exp_f32 v95, v95
  v_cvt_pk_bf16_f32 v102, v92, v93
  v_cvt_pk_bf16_f32 v103, v94, v95
  v_mfma_f32_32x32x16_bf16 v[48:63], v[128:131], v[96:99], v[48:63]
  ds_read_b128 v[112:115], v3 offset:12288
  v_exp_f32 v64, v64
  v_exp_f32 v65, v65
  ds_read_b128 v[116:119], v3 offset:13312
  v_exp_f32 v66, v66
  v_cvt_pk_bf16_f32 v96, v64, v65
  ds_read_b128 v[120:123], v3 offset:10240
  v_exp_f32 v67, v67
  v_exp_f32 v68, v68
  v_mfma_f32_32x32x16_bf16 v[80:95], v[104:107], v[24:27], 0
  ds_read_b128 v[124:127], v3 offset:11264
  v_cvt_pk_bf16_f32 v97, v66, v67
  v_exp_f32 v69, v69
  v_exp_f32 v70, v70
  v_exp_f32 v71, v71
  v_cvt_pk_bf16_f32 v98, v68, v69
  v_exp_f32 v72, v72
  s_mov_b32 m0, s43
  s_add_u32 s43, s43, 8192
  buffer_load_dwordx4 v11, s[44:47], s101 offen lds
  s_add_u32 s101, s101, 57344
  v_mfma_f32_32x32x16_bf16 v[80:95], v[108:111], v[28:31], v[80:95]
  v_exp_f32 v73, v73
  v_cvt_pk_bf16_f32 v99, v70, v71
  v_exp_f32 v74, v74
  v_exp_f32 v75, v75
  v_exp_f32 v76, v76
  v_mfma_f32_32x32x16_bf16 v[48:63], v[132:135], v[100:103], v[48:63]
  v_exp_f32 v77, v77
  v_cvt_pk_bf16_f32 v100, v72, v73
  v_exp_f32 v78, v78
  v_cvt_pk_bf16_f32 v101, v74, v75
  v_exp_f32 v79, v79
  v_cvt_pk_bf16_f32 v102, v76, v77
  v_cvt_pk_bf16_f32 v103, v78, v79
  s_waitcnt lgkmcnt(0)
  v_mfma_f32_32x32x16_bf16 v[32:47], v[120:123], v[96:99], v[32:47]
  v_exp_f32 v80, v80
  v_exp_f32 v81, v81
  v_exp_f32 v82, v82
  v_cvt_pk_bf16_f32 v96, v80, v81
  v_exp_f32 v83, v83
  v_exp_f32 v84, v84
  v_mfma_f32_32x32x16_bf16 v[64:79], v[112:115], v[16:19], 0
  v_cvt_pk_bf16_f32 v97, v82, v83
  v_exp_f32 v85, v85
  v_exp_f32 v86, v86
  v_exp_f32 v87, v87
  v_cvt_pk_bf16_f32 v98, v84, v85
  v_exp_f32 v88, v88
  v_mfma_f32_32x32x16_bf16 v[64:79], v[116:119], v[20:23], v[64:79]
  v_exp_f32 v89, v89
  v_cvt_pk_bf16_f32 v99, v86, v87
  v_exp_f32 v90, v90
  v_exp_f32 v91, v91
  v_exp_f32 v92, v92
  v_mfma_f32_32x32x16_bf16 v[32:47], v[124:127], v[100:103], v[32:47]
  v_exp_f32 v93, v93
  v_cvt_pk_bf16_f32 v100, v88, v89
  v_exp_f32 v94, v94
  v_cvt_pk_bf16_f32 v101, v90, v91
  v_exp_f32 v95, v95
  v_cvt_pk_bf16_f32 v102, v92, v93
  v_cvt_pk_bf16_f32 v103, v94, v95
  s_waitcnt vmcnt(1) lgkmcnt(0)
  s_barrier
  v_mfma_f32_32x32x16_bf16 v[48:63], v[120:123], v[96:99], v[48:63]
  ds_read_b128 v[104:107], v4
  v_exp_f32 v64, v64
  v_exp_f32 v65, v65
  ds_read_b128 v[108:111], v4 offset:1024
  v_exp_f32 v66, v66
  v_cvt_pk_bf16_f32 v96, v64, v65
  ds_read_b128 v[128:131], v3 offset:14336
  v_exp_f32 v67, v67
  v_exp_f32 v68, v68
  v_mfma_f32_32x32x16_bf16 v[80:95], v[112:115], v[24:27], 0
  ds_read_b128 v[132:135], v3 offset:15360
  v_cvt_pk_bf16_f32 v97, v66, v67
  v_exp_f32 v69, v69
  s_and_b32 s53, s99, 7
  s_lshl_b32 s53, s53, 15
  s_add_u32 s53, s53, s98
  s_add_u32 s99, s99, 1
  s_add_u32 s68, s67, s40
  s_mov_b32 m0, s68
  s_nop 0
  buffer_load_dwordx4 v2, s[36:39], s53 offen offset:0 sc1 lds
  v_exp_f32 v70, v70
  v_exp_f32 v71, v71
  v_cvt_pk_bf16_f32 v98, v68, v69
  v_exp_f32 v72, v72
  v_mfma_f32_32x32x16_bf16 v[80:95], v[116:119], v[28:31], v[80:95]
  v_exp_f32 v73, v73
  v_cvt_pk_bf16_f32 v99, v70, v71
  v_exp_f32 v74, v74
  v_exp_f32 v75, v75
  v_exp_f32 v76, v76
  v_mfma_f32_32x32x16_bf16 v[48:63], v[124:127], v[100:103], v[48:63]
  v_exp_f32 v77, v77
  v_cvt_pk_bf16_f32 v100, v72, v73
  v_exp_f32 v78, v78
  v_cvt_pk_bf16_f32 v101, v74, v75
  v_exp_f32 v79, v79
  v_cvt_pk_bf16_f32 v102, v76, v77
  v_cvt_pk_bf16_f32 v103, v78, v79
  s_waitcnt lgkmcnt(0)
  v_mfma_f32_32x32x16_bf16 v[32:47], v[128:131], v[96:99], v[32:47]
  v_exp_f32 v80, v80
  v_exp_f32 v81, v81
  v_exp_f32 v82, v82
  v_cvt_pk_bf16_f32 v96, v80, v81
  v_exp_f32 v83, v83
  v_exp_f32 v84, v84
  v_mfma_f32_32x32x16_bf16 v[64:79], v[104:107], v[16:19], 0
  v_cvt_pk_bf16_f32 v97, v82, v83
  v_exp_f32 v85, v85
  s_mov_b32 m0, s68
  s_nop 0
  buffer_load_dwordx4 v2, s[36:39], s53 offen offset:1024 sc1 lds
  v_exp_f32 v86, v86
  v_exp_f32 v87, v87
  v_cvt_pk_bf16_f32 v98, v84, v85
  v_exp_f32 v88, v88
  v_mfma_f32_32x32x16_bf16 v[64:79], v[108:111], v[20:23], v[64:79]
  v_exp_f32 v89, v89
  v_cvt_pk_bf16_f32 v99, v86, v87
  v_exp_f32 v90, v90
  v_exp_f32 v91, v91
  v_exp_f32 v92, v92
  v_mov_b32 v3, v4
  s_add_u32 s49, s49, 32768
  s_cmp_eq_u32 s49, 98304
  s_cselect_b32 s49, 0, s49
  v_mfma_f32_32x32x16_bf16 v[32:47], v[132:135], v[100:103], v[32:47]
  v_exp_f32 v93, v93
  v_add_u32 v4, s49, v6
  v_cvt_pk_bf16_f32 v100, v88, v89
  v_exp_f32 v94, v94
  s_add_u32 s48, s48, 1
  v_cvt_pk_bf16_f32 v101, v90, v91
  v_exp_f32 v95, v95
  s_cmp_lt_u32 s48, 6
  v_cvt_pk_bf16_f32 v102, v92, v93
  v_cvt_pk_bf16_f32 v103, v94, v95
  s_cbranch_scc1 L_loop
  v_mfma_f32_32x32x16_bf16 v[48:63], v[128:131], v[96:99], v[48:63]
  ds_read_b128 v[112:115], v3 offset:4096
  v_exp_f32 v64, v64
  v_exp_f32 v65, v65
  ds_read_b128 v[116:119], v3 offset:5120
  v_exp_f32 v66, v66
  v_cvt_pk_bf16_f32 v96, v64, v65
  ds_read_b128 v[120:123], v3 offset:2048
  v_exp_f32 v67, v67
  v_exp_f32 v68, v68
  v_mfma_f32_32x32x16_bf16 v[80:95], v[104:107], v[24:27], 0
  ds_read_b128 v[124:127], v3 offset:3072
  v_cvt_pk_bf16_f32 v97, v66, v67
  v_exp_f32 v69, v69
  v_exp_f32 v70, v70
  v_exp_f32 v71, v71
  v_cvt_pk_bf16_f32 v98, v68, v69
  v_exp_f32 v72, v72
  s_mov_b32 m0, s68
  s_nop 0
  buffer_load_dwordx4 v2, s[36:39], s53 offen offset:2048 sc1 lds
  v_mfma_f32_32x32x16_bf16 v[80:95], v[108:111], v[28:31], v[80:95]
  v_exp_f32 v73, v73
  v_cvt_pk_bf16_f32 v99, v70, v71
  v_exp_f32 v74, v74
  v_exp_f32 v75, v75
  v_exp_f32 v76, v76
  v_mfma_f32_32x32x16_bf16 v[48:63], v[132:135], v[100:103], v[48:63]
  v_exp_f32 v77, v77
  v_cvt_pk_bf16_f32 v100, v72, v73
  v_exp_f32 v78, v78
  v_cvt_pk_bf16_f32 v101, v74, v75
  v_exp_f32 v79, v79
  v_cvt_pk_bf16_f32 v102, v76, v77
  v_cvt_pk_bf16_f32 v103, v78, v79
  s_waitcnt lgkmcnt(0)
  v_mfma_f32_32x32x16_bf16 v[32:47], v[120:123], v[96:99], v[32:47]
  v_exp_f32 v80, v80
  v_exp_f32 v81, v81
  v_exp_f32 v82, v82
  v_cvt_pk_bf16_f32 v96, v80, v81
  v_exp_f32 v83, v83
  v_exp_f32 v84, v84
  v_mfma_f32_32x32x16_bf16 v[64:79], v[112:115], v[16:19], 0
  v_cvt_pk_bf16_f32 v97, v82, v83
  v_exp_f32 v85, v85
  v_exp_f32 v86, v86
  v_exp_f32 v87, v87
  v_cvt_pk_bf16_f32 v98, v84, v85
  v_exp_f32 v88, v88
  s_mov_b32 m0, s68
  s_nop 0
  buffer_load_dwordx4 v2, s[36:39], s53 offen offset:3072 sc1 lds
  s_add_u32 s67, s67, 32768
  s_cmp_eq_u32 s67, 98304
  s_cselect_b32 s67, 0, s67
  v_mfma_f32_32x32x16_bf16 v[64:79], v[116:119], v[20:23], v[64:79]
  v_exp_f32 v89, v89
  v_cvt_pk_bf16_f32 v99, v86, v87
  v_exp_f32 v90, v90
  v_exp_f32 v91, v91
  v_exp_f32 v92, v92
  v_mfma_f32_32x32x16_bf16 v[32:47], v[124:127], v[100:103], v[32:47]
  v_exp_f32 v93, v93
  v_cvt_pk_bf16_f32 v100, v88, v89
  v_exp_f32 v94, v94
  v_cvt_pk_bf16_f32 v101, v90, v91
  v_exp_f32 v95, v95
  v_cvt_pk_bf16_f32 v102, v92, v93
  v_cvt_pk_bf16_f32 v103, v94, v95
  v_mfma_f32_32x32x16_bf16 v[48:63], v[120:123], v[96:99], v[48:63]
  ds_read_b128 v[104:107], v3 offset:8192
  v_exp_f32 v64, v64
  v_exp_f32 v65, v65
  ds_read_b128 v[108:111], v3 offset:9216
  v_exp_f32 v66, v66
  v_cvt_pk_bf16_f32 v96, v64, v65
  ds_read_b128 v[128:131], v3 offset:6144
  v_exp_f32 v67, v67
  v_exp_f32 v68, v68
  v_mfma_f32_32x32x16_bf16 v[80:95], v[112:115], v[24:27], 0
  ds_read_b128 v[132:135], v3 offset:7168
  v_cvt_pk_bf16_f32 v97, v66, v67
  v_exp_f32 v69, v69
  v_exp_f32 v70, v70
  v_exp_f32 v71, v71
  v_cvt_pk_bf16_f32 v98, v68, v69
  v_exp_f32 v72, v72
  v_mfma_f32_32x32x16_bf16 v[80:95], v[116:119], v[28:31], v[80:95]
  v_exp_f32 v73, v73
  v_cvt_pk_bf16_f32 v99, v70, v71
  v_exp_f32 v74, v74
  v_exp_f32 v75, v75
  v_exp_f32 v76, v76
  v_mfma_f32_32x32x16_bf16 v[48:63], v[124:127], v[100:103], v[48:63]
  v_exp_f32 v77, v77
  v_cvt_pk_bf16_f32 v100, v72, v73
  v_exp_f32 v78, v78
  v_cvt_pk_bf16_f32 v101, v74, v75
  v_exp_f32 v79, v79
  v_cvt_pk_bf16_f32 v102, v76, v77
  v_cvt_pk_bf16_f32 v103, v78, v79
  s_waitcnt lgkmcnt(0)
  v_mfma_f32_32x32x16_bf16 v[32:47], v[128:131], v[96:99], v[32:47]
  v_exp_f32 v80, v80
  v_exp_f32 v81, v81
  v_exp_f32 v82, v82
  v_cvt_pk_bf16_f32 v96, v80, v81
  v_exp_f32 v83, v83
  v_exp_f32 v84, v84
  v_mfma_f32_32x32x16_bf16 v[64:79], v[104:107], v[16:19], 0
  v_cvt_pk_bf16_f32 v97, v82, v83
  v_exp_f32 v85, v85
  v_exp_f32 v86, v86
  v_exp_f32 v87, v87
  v_cvt_pk_bf16_f32 v98, v84, v85
  v_exp_f32 v88, v88
  v_mfma_f32_32x32x16_bf16 v[64:79], v[108:111], v[20:23], v[64:79]
  v_exp_f32 v89, v89
  v_cvt_pk_bf16_f32 v99, v86, v87
  v_exp_f32 v90, v90
  v_exp_f32 v91, v91
  v_exp_f32 v92, v92
  v_mfma_f32_32x32x16_bf16 v[32:47], v[132:135], v[100:103], v[32:47]
  v_exp_f32 v93, v93
  v_cvt_pk_bf16_f32 v100, v88, v89
  v_exp_f32 v94, v94
  v_cvt_pk_bf16_f32 v101, v90, v91
  v_exp_f32 v95, v95
  v_cvt_pk_bf16_f32 v102, v92, v93
  v_cvt_pk_bf16_f32 v103, v94, v95
  v_mfma_f32_32x32x16_bf16 v[48:63], v[128:131], v[96:99], v[48:63]
  ds_read_b128 v[112:115], v3 offset:12288
  v_exp_f32 v64, v64
  v_exp_f32 v65, v65
  ds_read_b128 v[116:119], v3 offset:13312
  v_exp_f32 v66, v66
  v_cvt_pk_bf16_f32 v96, v64, v65
  ds_read_b128 v[120:123], v3 offset:10240
  v_exp_f32 v67, v67
  v_exp_f32 v68, v68
  v_mfma_f32_32x32x16_bf16 v[80:95], v[104:107], v[24:27], 0
  ds_read_b128 v[124:127], v3 offset:11264
  v_cvt_pk_bf16_f32 v97, v66, v67
  v_exp_f32 v69, v69
  v_exp_f32 v70, v70
  v_exp_f32 v71, v71
  v_cvt_pk_bf16_f32 v98, v68, v69
  v_exp_f32 v72, v72
  v_mfma_f32_32x32x16_bf16 v[80:95], v[108:111], v[28:31], v[80:95]
  v_exp_f32 v73, v73
  v_cvt_pk_bf16_f32 v99, v70, v71
  v_exp_f32 v74, v74
  v_exp_f32 v75, v75
  v_exp_f32 v76, v76
  v_mfma_f32_32x32x16_bf16 v[48:63], v[132:135], v[100:103], v[48:63]
  v_exp_f32 v77, v77
  v_cvt_pk_bf16_f32 v100, v72, v73
  v_exp_f32 v78, v78
  v_cvt_pk_bf16_f32 v101, v74, v75
  v_exp_f32 v79, v79
  v_cvt_pk_bf16_f32 v102, v76, v77
  v_cvt_pk_bf16_f32 v103, v78, v79
  s_waitcnt lgkmcnt(0)
  v_mfma_f32_32x32x16_bf16 v[32:47], v[120:123], v[96:99], v[32:47]
  v_exp_f32 v80, v80
  v_exp_f32 v81, v81
  v_exp_f32 v82, v82
  v_cvt_pk_bf16_f32 v96, v80, v81
  v_exp_f32 v83, v83
  v_exp_f32 v84, v84
  v_mfma_f32_32x32x16_bf16 v[64:79], v[112:115], v[16:19], 0
  v_cvt_pk_bf16_f32 v97, v82, v83
  v_exp_f32 v85, v85
  v_exp_f32 v86, v86
  v_exp_f32 v87, v87
  v_cvt_pk_bf16_f32 v98, v84, v85
  v_exp_f32 v88, v88
  v_mfma_f32_32x32x16_bf16 v[64:79], v[116:119], v[20:23], v[64:79]
  v_exp_f32 v89, v89
  v_cvt_pk_bf16_f32 v99, v86, v87
  v_exp_f32 v90, v90
  v_exp_f32 v91, v91
  v_exp_f32 v92, v92
  v_mfma_f32_32x32x16_bf16 v[32:47], v[124:127], v[100:103], v[32:47]
  v_exp_f32 v93, v93
  v_cvt_pk_bf16_f32 v100, v88, v89
  v_exp_f32 v94, v94
  v_cvt_pk_bf16_f32 v101, v90, v91
  v_exp_f32 v95, v95
  v_cvt_pk_bf16_f32 v102, v92, v93
  v_cvt_pk_bf16_f32 v103, v94, v95
  s_waitcnt vmcnt(0) lgkmcnt(0)
  s_barrier
  v_mfma_f32_32x32x16_bf16 v[48:63], v[120:123], v[96:99], v[48:63]
  ds_read_b128 v[104:107], v4
  v_exp_f32 v64, v64
  v_exp_f32 v65, v65
  ds_read_b128 v[108:111], v4 offset:1024
  v_exp_f32 v66, v66
  v_cvt_pk_bf16_f32 v96, v64, v65
  ds_read_b128 v[128:131], v3 offset:14336
  v_exp_f32 v67, v67
  v_exp_f32 v68, v68
  v_mfma_f32_32x32x16_bf16 v[80:95], v[112:115], v[24:27], 0
  ds_read_b128 v[132:135], v3 offset:15360
  v_cvt_pk_bf16_f32 v97, v66, v67
  v_exp_f32 v69, v69
  v_lshrrev_b32 v12, 3, v1
  v_lshlrev_b32 v12, 6, v12
  v_and_b32 v13, 7, v1
  v_add_u32 v12, v12, v13
  v_mul_u32_u24 v12, 896, v12
  buffer_load_dword v240, v12, s[72:75], s100 offen
  v_exp_f32 v70, v70
  v_exp_f32 v71, v71
  v_cvt_pk_bf16_f32 v98, v68, v69
  v_exp_f32 v72, v72
  v_mfma_f32_32x32x16_bf16 v[80:95], v[116:119], v[28:31], v[80:95]
  v_exp_f32 v73, v73
  v_cvt_pk_bf16_f32 v99, v70, v71
  v_exp_f32 v74, v74
  v_exp_f32 v75, v75
  v_exp_f32 v76, v76
  v_mfma_f32_32x32x16_bf16 v[48:63], v[124:127], v[100:103], v[48:63]
  v_exp_f32 v77, v77
  v_cvt_pk_bf16_f32 v100, v72, v73
  v_exp_f32 v78, v78
  v_cvt_pk_bf16_f32 v101, v74, v75
  v_exp_f32 v79, v79
  v_cvt_pk_bf16_f32 v102, v76, v77
  v_cvt_pk_bf16_f32 v103, v78, v79
  s_waitcnt lgkmcnt(0)
  v_mfma_f32_32x32x16_bf16 v[32:47], v[128:131], v[96:99], v[32:47]
  v_exp_f32 v80, v80
  v_exp_f32 v81, v81
  v_exp_f32 v82, v82
  v_cvt_pk_bf16_f32 v96, v80, v81
  v_exp_f32 v83, v83
  v_exp_f32 v84, v84
  v_mfma_f32_32x32x16_bf16 v[64:79], v[104:107], v[16:19], 0
  v_cvt_pk_bf16_f32 v97, v82, v83
  v_exp_f32 v85, v85
  buffer_load_dword v241, v12, s[72:75], s100 offen offset:124
  v_exp_f32 v86, v86
  v_exp_f32 v87, v87
  v_cvt_pk_bf16_f32 v98, v84, v85
  v_exp_f32 v88, v88
  v_mfma_f32_32x32x16_bf16 v[64:79], v[108:111], v[20:23], v[64:79]
  v_exp_f32 v89, v89
  v_cvt_pk_bf16_f32 v99, v86, v87
  v_exp_f32 v90, v90
  v_exp_f32 v91, v91
  v_exp_f32 v92, v92
  v_mov_b32 v3, v4
  s_add_u32 s49, s49, 32768
  s_cmp_eq_u32 s49, 98304
  s_cselect_b32 s49, 0, s49
  v_mfma_f32_32x32x16_bf16 v[32:47], v[132:135], v[100:103], v[32:47]
  v_exp_f32 v93, v93
  v_add_u32 v4, s49, v6
  v_cvt_pk_bf16_f32 v100, v88, v89
  v_exp_f32 v94, v94
  v_cvt_pk_bf16_f32 v101, v90, v91
  v_exp_f32 v95, v95
  v_cvt_pk_bf16_f32 v102, v92, v93
  v_cvt_pk_bf16_f32 v103, v94, v95
  s_barrier
  v_mfma_f32_32x32x16_bf16 v[48:63], v[128:131], v[96:99], v[48:63]
  ds_read_b128 v[112:115], v3 offset:4096
  v_exp_f32 v64, v64
  v_exp_f32 v65, v65
  ds_read_b128 v[116:119], v3 offset:5120
  v_exp_f32 v66, v66
  v_cvt_pk_bf16_f32 v96, v64, v65
  ds_read_b128 v[120:123], v3 offset:2048
  v_exp_f32 v67, v67
  v_exp_f32 v68, v68
  v_mfma_f32_32x32x16_bf16 v[80:95], v[104:107], v[24:27], 0
  ds_read_b128 v[124:127], v3 offset:3072
  v_cvt_pk_bf16_f32 v97, v66, v67
  v_exp_f32 v69, v69
  v_exp_f32 v70, v70
  v_exp_f32 v71, v71
  s_add_u32 m0, s61, 40960
  s_add_u32 s64, s100, 0
  buffer_load_dwordx4 v11, s[72:75], s64 offen lds
  v_cvt_pk_bf16_f32 v98, v68, v69
  v_exp_f32 v72, v72
  v_mfma_f32_32x32x16_bf16 v[80:95], v[108:111], v[28:31], v[80:95]
  v_exp_f32 v73, v73
  v_cvt_pk_bf16_f32 v99, v70, v71
  v_exp_f32 v74, v74
  v_exp_f32 v75, v75
  v_exp_f32 v76, v76
  v_mfma_f32_32x32x16_bf16 v[48:63], v[132:135], v[100:103], v[48:63]
  v_exp_f32 v77, v77
  v_cvt_pk_bf16_f32 v100, v72, v73
  v_exp_f32 v78, v78
  v_cvt_pk_bf16_f32 v101, v74, v75
  v_exp_f32 v79, v79
  v_cvt_pk_bf16_f32 v102, v76, v77
  v_cvt_pk_bf16_f32 v103, v78, v79
  s_waitcnt lgkmcnt(0)
  v_mfma_f32_32x32x16_bf16 v[32:47], v[120:123], v[96:99], v[32:47]
  v_exp_f32 v80, v80
  v_exp_f32 v81, v81
  v_exp_f32 v82, v82
  v_cvt_pk_bf16_f32 v96, v80, v81
  v_exp_f32 v83, v83
  v_exp_f32 v84, v84
  v_mfma_f32_32x32x16_bf16 v[64:79], v[112:115], v[16:19], 0
  v_cvt_pk_bf16_f32 v97, v82, v83
  v_exp_f32 v85, v85
  v_exp_f32 v86, v86
  v_exp_f32 v87, v87
  s_add_u32 m0, s61, 49152
  s_add_u32 s64, s100, 57344
  buffer_load_dwordx4 v11, s[72:75], s64 offen lds
  v_cvt_pk_bf16_f32 v98, v84, v85
  v_exp_f32 v88, v88
  v_mfma_f32_32x32x16_bf16 v[64:79], v[116:119], v[20:23], v[64:79]
  v_exp_f32 v89, v89
  v_cvt_pk_bf16_f32 v99, v86, v87
  v_exp_f32 v90, v90
  v_exp_f32 v91, v91
  v_exp_f32 v92, v92
  v_mfma_f32_32x32x16_bf16 v[32:47], v[124:127], v[100:103], v[32:47]
  v_exp_f32 v93, v93
  v_cvt_pk_bf16_f32 v100, v88, v89
  v_exp_f32 v94, v94
  v_cvt_pk_bf16_f32 v101, v90, v91
  v_exp_f32 v95, v95
  v_cvt_pk_bf16_f32 v102, v92, v93
  v_cvt_pk_bf16_f32 v103, v94, v95
  v_mfma_f32_32x32x16_bf16 v[48:63], v[120:123], v[96:99], v[48:63]
  ds_read_b128 v[104:107], v3 offset:8192
  v_exp_f32 v64, v64
  v_exp_f32 v65, v65
  ds_read_b128 v[108:111], v3 offset:9216
  v_exp_f32 v66, v66
  v_cvt_pk_bf16_f32 v96, v64, v65
  ds_read_b128 v[128:131], v3 offset:6144
  v_exp_f32 v67, v67
  v_exp_f32 v68, v68
  v_mfma_f32_32x32x16_bf16 v[80:95], v[112:115], v[24:27], 0
  ds_read_b128 v[132:135], v3 offset:7168
  v_cvt_pk_bf16_f32 v97, v66, v67
  v_exp_f32 v69, v69
  v_exp_f32 v70, v70
  v_exp_f32 v71, v71
  s_add_u32 m0, s61, 57344
  s_add_u32 s64, s100, 114688
  buffer_load_dwordx4 v11, s[72:75], s64 offen lds
  v_cvt_pk_bf16_f32 v98, v68, v69
  v_exp_f32 v72, v72
  v_mfma_f32_32x32x16_bf16 v[80:95], v[116:119], v[28:31], v[80:95]
  v_exp_f32 v73, v73
  v_cvt_pk_bf16_f32 v99, v70, v71
  v_exp_f32 v74, v74
  v_exp_f32 v75, v75
  v_exp_f32 v76, v76
  v_mfma_f32_32x32x16_bf16 v[48:63], v[124:127], v[100:103], v[48:63]
  v_exp_f32 v77, v77
  v_cvt_pk_bf16_f32 v100, v72, v73
  v_exp_f32 v78, v78
  v_cvt_pk_bf16_f32 v101, v74, v75
  v_exp_f32 v79, v79
  v_cvt_pk_bf16_f32 v102, v76, v77
  v_cvt_pk_bf16_f32 v103, v78, v79
  s_waitcnt lgkmcnt(0)
  v_mfma_f32_32x32x16_bf16 v[32:47], v[128:131], v[96:99], v[32:47]
  v_exp_f32 v80, v80
  v_exp_f32 v81, v81
  v_exp_f32 v82, v82
  v_cvt_pk_bf16_f32 v96, v80, v81
  v_exp_f32 v83, v83
  v_exp_f32 v84, v84
  v_mfma_f32_32x32x16_bf16 v[64:79], v[104:107], v[16:19], 0
  v_cvt_pk_bf16_f32 v97, v82, v83
  v_exp_f32 v85, v85
  v_exp_f32 v86, v86
  v_exp_f32 v87, v87
  s_add_u32 m0, s61, 65536
  s_add_u32 s64, s100, 172032
  buffer_load_dwordx4 v11, s[72:75], s64 offen lds
  v_cvt_pk_bf16_f32 v98, v84, v85
  v_exp_f32 v88, v88
  v_mfma_f32_32x32x16_bf16 v[64:79], v[108:111], v[20:23], v[64:79]
  v_exp_f32 v89, v89
  v_cvt_pk_bf16_f32 v99, v86, v87
  v_exp_f32 v90, v90
  v_exp_f32 v91, v91
  v_exp_f32 v92, v92
  v_mfma_f32_32x32x16_bf16 v[32:47], v[132:135], v[100:103], v[32:47]
  v_exp_f32 v93, v93
  v_cvt_pk_bf16_f32 v100, v88, v89
  v_exp_f32 v94, v94
  v_cvt_pk_bf16_f32 v101, v90, v91
  v_exp_f32 v95, v95
  v_cvt_pk_bf16_f32 v102, v92, v93
  v_cvt_pk_bf16_f32 v103, v94, v95
  v_mfma_f32_32x32x16_bf16 v[48:63], v[128:131], v[96:99], v[48:63]
  ds_read_b128 v[112:115], v3 offset:12288
  v_exp_f32 v64, v64
  v_exp_f32 v65, v65
  ds_read_b128 v[116:119], v3 offset:13312
  v_exp_f32 v66, v66
  v_cvt_pk_bf16_f32 v96, v64, v65
  ds_read_b128 v[120:123], v3 offset:10240
  v_exp_f32 v67, v67
  v_exp_f32 v68, v68
  v_mfma_f32_32x32x16_bf16 v[80:95], v[104:107], v[24:27], 0
  ds_read_b128 v[124:127], v3 offset:11264
  v_cvt_pk_bf16_f32 v97, v66, v67
  v_exp_f32 v69, v69
  v_exp_f32 v70, v70
  v_exp_f32 v71, v71
  s_add_u32 m0, s61, 73728
  s_add_u32 s64, s100, 229376
  buffer_load_dwordx4 v11, s[72:75], s64 offen lds
  v_cvt_pk_bf16_f32 v98, v68, v69
  v_exp_f32 v72, v72
  v_mfma_f32_32x32x16_bf16 v[80:95], v[108:111], v[28:31], v[80:95]
  v_exp_f32 v73, v73
  v_cvt_pk_bf16_f32 v99, v70, v71
  v_exp_f32 v74, v74
  v_exp_f32 v75, v75
  v_exp_f32 v76, v76
  v_mfma_f32_32x32x16_bf16 v[48:63], v[132:135], v[100:103], v[48:63]
  v_exp_f32 v77, v77
  v_cvt_pk_bf16_f32 v100, v72, v73
  v_exp_f32 v78, v78
  v_cvt_pk_bf16_f32 v101, v74, v75
  v_exp_f32 v79, v79
  v_cvt_pk_bf16_f32 v102, v76, v77
  v_cvt_pk_bf16_f32 v103, v78, v79
  s_waitcnt lgkmcnt(0)
  v_mfma_f32_32x32x16_bf16 v[32:47], v[120:123], v[96:99], v[32:47]
  v_exp_f32 v80, v80
  v_exp_f32 v81, v81
  v_exp_f32 v82, v82
  v_cvt_pk_bf16_f32 v96, v80, v81
  v_exp_f32 v83, v83
  v_exp_f32 v84, v84
  v_mfma_f32_32x32x16_bf16 v[64:79], v[112:115], v[16:19], 0
  v_cvt_pk_bf16_f32 v97, v82, v83
  v_exp_f32 v85, v85
  v_exp_f32 v86, v86
  v_exp_f32 v87, v87
  s_add_u32 m0, s61, 81920
  s_add_u32 s64, s100, 286720
  buffer_load_dwordx4 v11, s[72:75], s64 offen lds
  v_cvt_pk_bf16_f32 v98, v84, v85
  v_exp_f32 v88, v88
  v_mfma_f32_32x32x16_bf16 v[64:79], v[116:119], v[20:23], v[64:79]
  v_exp_f32 v89, v89
  v_cvt_pk_bf16_f32 v99, v86, v87
  v_exp_f32 v90, v90
  v_exp_f32 v91, v91
  v_exp_f32 v92, v92
  v_mfma_f32_32x32x16_bf16 v[32:47], v[124:127], v[100:103], v[32:47]
  v_exp_f32 v93, v93
  v_cvt_pk_bf16_f32 v100, v88, v89
  v_exp_f32 v94, v94
  v_cvt_pk_bf16_f32 v101, v90, v91
  v_exp_f32 v95, v95
  v_cvt_pk_bf16_f32 v102, v92, v93
  v_cvt_pk_bf16_f32 v103, v94, v95
  v_mfma_f32_32x32x16_bf16 v[48:63], v[120:123], v[96:99], v[48:63]
  ds_read_b128 v[104:107], v4
  v_exp_f32 v64, v64
  v_exp_f32 v65, v65
  ds_read_b128 v[108:111], v4 offset:1024
  v_exp_f32 v66, v66
  v_cvt_pk_bf16_f32 v96, v64, v65
  ds_read_b128 v[128:131], v3 offset:14336
  v_exp_f32 v67, v67
  v_exp_f32 v68, v68
  v_mfma_f32_32x32x16_bf16 v[80:95], v[112:115], v[24:27], 0
  ds_read_b128 v[132:135], v3 offset:15360
  v_cvt_pk_bf16_f32 v97, v66, v67
  v_exp_f32 v69, v69
  v_exp_f32 v70, v70
  v_exp_f32 v71, v71
  s_add_u32 m0, s61, 90112
  s_add_u32 s64, s100, 344064
  buffer_load_dwordx4 v11, s[72:75], s64 offen lds
  v_cvt_pk_bf16_f32 v98, v68, v69
  v_exp_f32 v72, v72
  v_mfma_f32_32x32x16_bf16 v[80:95], v[116:119], v[28:31], v[80:95]
  v_exp_f32 v73, v73
  v_cvt_pk_bf16_f32 v99, v70, v71
  v_exp_f32 v74, v74
  v_exp_f32 v75, v75
  v_exp_f32 v76, v76
  v_mfma_f32_32x32x16_bf16 v[48:63], v[124:127], v[100:103], v[48:63]
  v_exp_f32 v77, v77
  v_cvt_pk_bf16_f32 v100, v72, v73
  v_exp_f32 v78, v78
  v_cvt_pk_bf16_f32 v101, v74, v75
  v_exp_f32 v79, v79
  v_cvt_pk_bf16_f32 v102, v76, v77
  v_cvt_pk_bf16_f32 v103, v78, v79
  s_waitcnt lgkmcnt(0)
  v_mfma_f32_32x32x16_bf16 v[32:47], v[128:131], v[96:99], v[32:47]
  v_exp_f32 v80, v80
  v_exp_f32 v81, v81
  v_exp_f32 v82, v82
  v_cvt_pk_bf16_f32 v96, v80, v81
  v_exp_f32 v83, v83
  v_exp_f32 v84, v84
  v_mfma_f32_32x32x16_bf16 v[64:79], v[104:107], v[16:19], 0
  v_cvt_pk_bf16_f32 v97, v82, v83
  v_exp_f32 v85, v85
  v_exp_f32 v86, v86
  v_exp_f32 v87, v87
  v_cvt_pk_bf16_f32 v98, v84, v85
  v_exp_f32 v88, v88
  v_mfma_f32_32x32x16_bf16 v[64:79], v[108:111], v[20:23], v[64:79]
  v_exp_f32 v89, v89
  v_cvt_pk_bf16_f32 v99, v86, v87
  v_exp_f32 v90, v90
  v_exp_f32 v91, v91
  v_exp_f32 v92, v92
  v_mfma_f32_32x32x16_bf16 v[32:47], v[132:135], v[100:103], v[32:47]
  v_exp_f32 v93, v93
  v_cvt_pk_bf16_f32 v100, v88, v89
  v_exp_f32 v94, v94
  v_cvt_pk_bf16_f32 v101, v90, v91
  v_exp_f32 v95, v95
  v_cvt_pk_bf16_f32 v102, v92, v93
  v_cvt_pk_bf16_f32 v103, v94, v95
  s_nop 1
  v_mfma_f32_32x32x16_bf16 v[48:63], v[128:131], v[96:99], v[48:63]
  v_mfma_f32_32x32x16_bf16 v[48:63], v[132:135], v[100:103], v[48:63]
  v_add_u32 v11, s40, v2
  s_xor_b32 s29, s6, 1
  s_lshl_b32 s29, s29, 12
  v_add_u32 v12, s29, v2
  s_lshl_b32 s29, s41, 16
  s_lshl_b32 s30, s3, 11
  s_add_u32 s29, s29, s30
  s_add_u32 s29, s29, 8388608
  s_barrier
  s_nop 3
  s_cmp_eq_u32 s96, 0
  s_cbranch_scc0 L_x1
  ds_write_b128 v11, v[48:51] offset:0
  ds_write_b128 v11, v[52:55] offset:1024
  ds_write_b128 v11, v[56:59] offset:2048
  ds_write_b128 v11, v[60:63] offset:3072
  s_waitcnt lgkmcnt(0)
  s_barrier
  ds_read_b128 v[64:67], v12 offset:0
  ds_read_b128 v[68:71], v12 offset:1024
  ds_read_b128 v[72:75], v12 offset:2048
  ds_read_b128 v[76:79], v12 offset:3072
  s_waitcnt lgkmcnt(3)
  v_add_f32 v32, v32, v64
  v_add_f32 v33, v33, v65
  v_add_f32 v34, v34, v66
  v_add_f32 v35, v35, v67
  s_waitcnt lgkmcnt(2)
  v_add_f32 v36, v36, v68
  v_add_f32 v37, v37, v69
  v_add_f32 v38, v38, v70
  v_add_f32 v39, v39, v71
  s_waitcnt lgkmcnt(1)
  v_add_f32 v40, v40, v72
  v_add_f32 v41, v41, v73
  v_add_f32 v42, v42, v74
  v_add_f32 v43, v43, v75
  s_waitcnt lgkmcnt(0)
  v_add_f32 v44, v44, v76
  v_add_f32 v45, v45, v77
  v_add_f32 v46, v46, v78
  v_add_f32 v47, v47, v79
  s_branch L_xd
L_x1:
  ds_write_b128 v11, v[32:35] offset:0
  ds_write_b128 v11, v[36:39] offset:1024
  ds_write_b128 v11, v[40:43] offset:2048
  ds_write_b128 v11, v[44:47] offset:3072
  s_waitcnt lgkmcnt(0)
  s_barrier
  ds_read_b128 v[64:67], v12 offset:0
  ds_read_b128 v[68:71], v12 offset:1024
  ds_read_b128 v[72:75], v12 offset:2048
  ds_read_b128 v[76:79], v12 offset:3072
  s_waitcnt lgkmcnt(3)
  v_add_f32 v32, v48, v64
  v_add_f32 v33, v49, v65
  v_add_f32 v34, v50, v66
  v_add_f32 v35, v51, v67
  s_waitcnt lgkmcnt(2)
  v_add_f32 v36, v52, v68
  v_add_f32 v37, v53, v69
  v_add_f32 v38, v54, v70
  v_add_f32 v39, v55, v71
  s_waitcnt lgkmcnt(1)
  v_add_f32 v40, v56, v72
  v_add_f32 v41, v57, v73
  v_add_f32 v42, v58, v74
  v_add_f32 v43, v59, v75
  s_waitcnt lgkmcnt(0)
  v_add_f32 v44, v60, v76
  v_add_f32 v45, v61, v77
  v_add_f32 v46, v62, v78
  v_add_f32 v47, v63, v79
L_xd:
  s_mov_b32 s59, 0
L_norm:
  s_mov_b32 s64, 0x71800000
  v_mov_b32 v13, v44
  v_mov_b32 v14, v44
  v_maximum3_f32 v15, |v32|, |v33|, |v34|
  v_maximum3_f32 v15, |v35|, |v36|, v15
  v_permlane32_swap_b32 v13, v14
  v_maximum3_f32 v15, |v37|, |v38|, v15
  v_maximum3_f32 v15, |v39|, |v40|, v15
  v_maximum3_f32 v15, |v41|, |v42|, v15
  v_maximum3_f32 v15, |v43|, |v44|, v15
  v_maximum3_f32 v15, |v45|, |v46|, v15
  v_rcp_f32 v13, v14
  v_maximum3_f32 v15, |v47|, |v14|, v15
  v_mul_f32 v13, v13, v250
  v_cmp_nle_f32 vcc, v15, s64
  v_mul_f32 v32, v32, v13
  v_mul_f32 v33, v33, v13
  v_mul_f32 v34, v34, v13
  v_mul_f32 v35, v35, v13
  v_mul_f32 v36, v36, v13
  v_mul_f32 v37, v37, v13
  v_mul_f32 v38, v38, v13
  v_mul_f32 v39, v39, v13
  v_mul_f32 v40, v40, v13
  v_mul_f32 v41, v41, v13
  v_mul_f32 v42, v42, v13
  v_mul_f32 v43, v43, v13
  s_cmp_lg_u32 s59, 0
  s_cbranch_scc1 L_norm_ok
  s_cmp_lg_u64 vcc, 0
  s_cbranch_scc1 L_fallback
L_norm_ok:
  v_mul_f32 v44, v44, v13
  v_mul_f32 v45, v45, v13
  v_mul_f32 v46, v46, v13
  v_mul_f32 v47, v47, v13
  s_mov_b64 exec, s[62:63]
  v_mov_b32 v44, 0
  v_mov_b32 v45, 0
  v_mov_b32 v46, 0
  v_mov_b32 v47, 0
  s_mov_b64 exec, -1
  v_cvt_pk_bf16_f32 v96, v32, v33
  v_cvt_pk_bf16_f32 v97, v34, v35
  v_cvt_pk_bf16_f32 v98, v36, v37
  v_cvt_pk_bf16_f32 v99, v38, v39
  buffer_store_dwordx4 v[96:99], v2, s[36:39], s29 offen sc1
  v_cvt_pk_bf16_f32 v100, v40, v41
  v_cvt_pk_bf16_f32 v101, v42, v43
  v_cvt_pk_bf16_f32 v102, v44, v45
  v_cvt_pk_bf16_f32 v103, v46, v47
  buffer_store_dwordx4 v[100:103], v2, s[36:39], s29 offen offset:1024 sc1
  s_lshr_b32 s7, s6, 2
  s_and_b32 s28, s6, 3
  v_lshrrev_b32 v5, 5, v1
  v_lshlrev_b32 v5, 2, v5
  v_bfe_u32 v6, v1, 2, 2
  v_add_u32 v5, v5, v6
  v_lshlrev_b32 v5, 7, v5
  v_bfe_u32 v7, v1, 4, 1
  v_lshlrev_b32 v7, 1, v7
  v_bfe_u32 v8, v1, 1, 1
  v_add_u32 v7, v7, v8
  v_bfe_u32 v8, v6, 1, 1
  v_lshlrev_b32 v8, 2, v8
  v_xor_b32 v7, v7, v8
  v_lshlrev_b32 v7, 4, v7
  v_add_u32 v5, v5, v7
  v_and_b32 v7, 1, v1
  v_lshlrev_b32 v7, 3, v7
  v_add_u32 v5, v5, v7
  v_xor_b32 v6, 64, v5
  s_mul_i32 s29, s28, 28672
  s_add_u32 s29, s29, 40960
  v_add_u32 v5, s29, v5
  v_add_u32 v6, s29, v6
  v_mov_b32 v13, 0
  v_and_b32 v10, 31, v1
  v_lshlrev_b32 v11, 3, v10
  s_lshr_b32 s66, s54, 2
  s_lshl_b32 s66, s66, 8
  s_add_u32 s66, s66, 12599296
  s_lshl_b32 s32, s54, 1
  s_add_u32 s32, s32, s7
  s_lshl_b32 s33, s32, 16
  s_lshl_b32 s34, s28, 14
  s_add_u32 s33, s33, s34
  s_add_u32 s33, s33, 8388608
  s_lshl_b32 s29, s7, 15
  s_lshl_b32 s30, s28, 12
  s_add_u32 s29, s29, s30
  v_add_u32 v16, s29, v2
  s_bfe_u32 s29, s6, 0x10001
  s_and_b32 s30, s6, 1
  s_lshl_b32 s31, s7, 15
  s_lshl_b32 s34, s29, 14
  s_add_u32 s31, s31, s34
  s_lshl_b32 s34, s30, 11
  s_add_u32 s31, s31, s34
  v_add_u32 v17, s31, v2
  v_mul_u32_u24 v18, 896, v10
  v_lshrrev_b32 v12, 5, v1
  v_lshlrev_b32 v12, 4, v12
  v_add_u32 v18, v18, v12
  s_lshl_b32 s31, s29, 6
  s_lshl_b32 s34, s30, 5
  s_add_u32 s31, s31, s34
  v_add_u32 v12, s31, v12
  v_cmp_gt_u32 vcc, 112, v12
  s_mul_i32 s34, s55, 112
  s_add_u32 s31, s31, s34
  s_mul_i32 s34, s32, 28672
  s_add_u32 s31, s31, s34
  v_mov_b32 v19, 0x7fffffff
  v_cndmask_b32 v18, v19, v18, vcc
  s_mov_b32 s48, s22
  s_mov_b32 s49, s23
  s_mov_b32 s50, 1835008
  s_mov_b32 s51, 0x20000
  s_waitcnt vmcnt(0)
  s_barrier
  s_cmp_lg_u32 s6, 0
  s_cbranch_scc1 L_noflag2
  s_lshl_b32 s64, s5, 8
  s_lshl_b32 s67, s3, 3
  s_add_u32 s64, s64, s67
  s_add_u32 s64, s64, 12599296
  v_mov_b32 v14, s56
  v_mov_b32 v15, s57
  s_mov_b64 exec, 1
  buffer_store_dwordx2 v[14:15], v13, s[36:39], s64 offen sc1
  s_mov_b64 exec, -1
L_noflag2:
  s_cmp_lg_u32 s6, 0
  s_cbranch_scc1 L_p2_done
  s_mov_b32 s58, 0
L_p2:
  buffer_load_dwordx2 v[14:15], v11, s[36:39], s66 offen sc1
  s_waitcnt vmcnt(0)
  v_cmp_eq_u64 vcc, s[56:57], v[14:15]
  s_add_u32 s58, s58, 1
  s_cmp_ge_u32 s58, 262144
  s_cbranch_scc1 L_p2_done
  s_cmp_eq_u64 vcc, exec
  s_cbranch_scc1 L_p2_done
  s_sleep 1
  s_branch L_p2
L_p2_done:
  s_barrier
  buffer_load_dwordx4 v[64:67], v2, s[36:39], s33 offen offset:0 sc1
  buffer_load_dwordx4 v[68:71], v2, s[36:39], s33 offen offset:1024 sc1
  buffer_load_dwordx4 v[72:75], v2, s[36:39], s33 offen offset:2048 sc1
  buffer_load_dwordx4 v[76:79], v2, s[36:39], s33 offen offset:3072 sc1
  s_add_u32 s33, s33, 4096
  buffer_load_dwordx4 v[80:83], v2, s[36:39], s33 offen offset:0 sc1
  buffer_load_dwordx4 v[84:87], v2, s[36:39], s33 offen offset:1024 sc1
  buffer_load_dwordx4 v[88:91], v2, s[36:39], s33 offen offset:2048 sc1
  buffer_load_dwordx4 v[92:95], v2, s[36:39], s33 offen offset:3072 sc1
  s_add_u32 s33, s33, 4096
  buffer_load_dwordx4 v[96:99], v2, s[36:39], s33 offen offset:0 sc1
  buffer_load_dwordx4 v[100:103], v2, s[36:39], s33 offen offset:1024 sc1
  buffer_load_dwordx4 v[104:107], v2, s[36:39], s33 offen offset:2048 sc1
  buffer_load_dwordx4 v[108:111], v2, s[36:39], s33 offen offset:3072 sc1
  s_add_u32 s33, s33, 4096
  buffer_load_dwordx4 v[112:115], v2, s[36:39], s33 offen offset:0 sc1
  buffer_load_dwordx4 v[116:119], v2, s[36:39], s33 offen offset:1024 sc1
  buffer_load_dwordx4 v[120:123], v2, s[36:39], s33 offen offset:2048 sc1
  buffer_load_dwordx4 v[124:127], v2, s[36:39], s33 offen offset:3072 sc1
  ds_read_b64_tr_b16 v[128:129], v5 offset:0
  ds_read_b64_tr_b16 v[130:131], v5 offset:1024
  ds_read_b64_tr_b16 v[132:133], v6 offset:0
  ds_read_b64_tr_b16 v[134:135], v6 offset:1024
  ds_read_b64_tr_b16 v[136:137], v5 offset:2048
  ds_read_b64_tr_b16 v[138:139], v5 offset:3072
  ds_read_b64_tr_b16 v[140:141], v6 offset:2048
  ds_read_b64_tr_b16 v[142:143], v6 offset:3072
  s_waitcnt vmcnt(15) lgkmcnt(4)
  v_mfma_f32_32x32x16_bf16 v[32:47], v[128:131], v[64:67], 0
  v_mfma_f32_32x32x16_bf16 v[48:63], v[132:135], v[64:67], 0
  ds_read_b64_tr_b16 v[128:129], v5 offset:3584
  ds_read_b64_tr_b16 v[130:131], v5 offset:4608
  ds_read_b64_tr_b16 v[132:133], v6 offset:3584
  ds_read_b64_tr_b16 v[134:135], v6 offset:4608
  s_waitcnt vmcnt(14) lgkmcnt(4)
  v_mfma_f32_32x32x16_bf16 v[32:47], v[136:139], v[68:71], v[32:47]
  v_mfma_f32_32x32x16_bf16 v[48:63], v[140:143], v[68:71], v[48:63]
  ds_read_b64_tr_b16 v[136:137], v5 offset:5632
  ds_read_b64_tr_b16 v[138:139], v5 offset:6656
  ds_read_b64_tr_b16 v[140:141], v6 offset:5632
  ds_read_b64_tr_b16 v[142:143], v6 offset:6656
  s_waitcnt vmcnt(13) lgkmcnt(4)
  v_mfma_f32_32x32x16_bf16 v[32:47], v[128:131], v[72:75], v[32:47]
  v_mfma_f32_32x32x16_bf16 v[48:63], v[132:135], v[72:75], v[48:63]
  ds_read_b64_tr_b16 v[128:129], v5 offset:7168
  ds_read_b64_tr_b16 v[130:131], v5 offset:8192
  ds_read_b64_tr_b16 v[132:133], v6 offset:7168
  ds_read_b64_tr_b16 v[134:135], v6 offset:8192
  s_waitcnt vmcnt(12) lgkmcnt(4)
  v_mfma_f32_32x32x16_bf16 v[32:47], v[136:139], v[76:79], v[32:47]
  v_mfma_f32_32x32x16_bf16 v[48:63], v[140:143], v[76:79], v[48:63]
  ds_read_b64_tr_b16 v[136:137], v5 offset:9216
  ds_read_b64_tr_b16 v[138:139], v5 offset:10240
  ds_read_b64_tr_b16 v[140:141], v6 offset:9216
  ds_read_b64_tr_b16 v[142:143], v6 offset:10240
  s_waitcnt vmcnt(11) lgkmcnt(4)
  v_mfma_f32_32x32x16_bf16 v[32:47], v[128:131], v[80:83], v[32:47]
  v_mfma_f32_32x32x16_bf16 v[48:63], v[132:135], v[80:83], v[48:63]
  ds_read_b64_tr_b16 v[128:129], v5 offset:10752
  ds_read_b64_tr_b16 v[130:131], v5 offset:11776
  ds_read_b64_tr_b16 v[132:133], v6 offset:10752
  ds_read_b64_tr_b16 v[134:135], v6 offset:11776
  s_waitcnt vmcnt(10) lgkmcnt(4)
  v_mfma_f32_32x32x16_bf16 v[32:47], v[136:139], v[84:87], v[32:47]
  v_mfma_f32_32x32x16_bf16 v[48:63], v[140:143], v[84:87], v[48:63]
  ds_read_b64_tr_b16 v[136:137], v5 offset:12800
  ds_read_b64_tr_b16 v[138:139], v5 offset:13824
  ds_read_b64_tr_b16 v[140:141], v6 offset:12800
  ds_read_b64_tr_b16 v[142:143], v6 offset:13824
  s_waitcnt vmcnt(9) lgkmcnt(4)
  v_mfma_f32_32x32x16_bf16 v[32:47], v[128:131], v[88:91], v[32:47]
  v_mfma_f32_32x32x16_bf16 v[48:63], v[132:135], v[88:91], v[48:63]
  ds_read_b64_tr_b16 v[128:129], v5 offset:14336
  ds_read_b64_tr_b16 v[130:131], v5 offset:15360
  ds_read_b64_tr_b16 v[132:133], v6 offset:14336
  ds_read_b64_tr_b16 v[134:135], v6 offset:15360
  s_waitcnt vmcnt(8) lgkmcnt(4)
  v_mfma_f32_32x32x16_bf16 v[32:47], v[136:139], v[92:95], v[32:47]
  v_mfma_f32_32x32x16_bf16 v[48:63], v[140:143], v[92:95], v[48:63]
  ds_read_b64_tr_b16 v[136:137], v5 offset:16384
  ds_read_b64_tr_b16 v[138:139], v5 offset:17408
  ds_read_b64_tr_b16 v[140:141], v6 offset:16384
  ds_read_b64_tr_b16 v[142:143], v6 offset:17408
  s_waitcnt vmcnt(7) lgkmcnt(4)
  v_mfma_f32_32x32x16_bf16 v[32:47], v[128:131], v[96:99], v[32:47]
  v_mfma_f32_32x32x16_bf16 v[48:63], v[132:135], v[96:99], v[48:63]
  ds_read_b64_tr_b16 v[128:129], v5 offset:17920
  ds_read_b64_tr_b16 v[130:131], v5 offset:18944
  ds_read_b64_tr_b16 v[132:133], v6 offset:17920
  ds_read_b64_tr_b16 v[134:135], v6 offset:18944
  s_waitcnt vmcnt(6) lgkmcnt(4)
  v_mfma_f32_32x32x16_bf16 v[32:47], v[136:139], v[100:103], v[32:47]
  v_mfma_f32_32x32x16_bf16 v[48:63], v[140:143], v[100:103], v[48:63]
  ds_read_b64_tr_b16 v[136:137], v5 offset:19968
  ds_read_b64_tr_b16 v[138:139], v5 offset:20992
  ds_read_b64_tr_b16 v[140:141], v6 offset:19968
  ds_read_b64_tr_b16 v[142:143], v6 offset:20992
  s_waitcnt vmcnt(5) lgkmcnt(4)
  v_mfma_f32_32x32x16_bf16 v[32:47], v[128:131], v[104:107], v[32:47]
  v_mfma_f32_32x32x16_bf16 v[48:63], v[132:135], v[104:107], v[48:63]
  ds_read_b64_tr_b16 v[128:129], v5 offset:21504
  ds_read_b64_tr_b16 v[130:131], v5 offset:22528
  ds_read_b64_tr_b16 v[132:133], v6 offset:21504
  ds_read_b64_tr_b16 v[134:135], v6 offset:22528
  s_waitcnt vmcnt(4) lgkmcnt(4)
  v_mfma_f32_32x32x16_bf16 v[32:47], v[136:139], v[108:111], v[32:47]
  v_mfma_f32_32x32x16_bf16 v[48:63], v[140:143], v[108:111], v[48:63]
  ds_read_b64_tr_b16 v[136:137], v5 offset:23552
  ds_read_b64_tr_b16 v[138:139], v5 offset:24576
  ds_read_b64_tr_b16 v[140:141], v6 offset:23552
  ds_read_b64_tr_b16 v[142:143], v6 offset:24576
  s_waitcnt vmcnt(3) lgkmcnt(4)
  v_mfma_f32_32x32x16_bf16 v[32:47], v[128:131], v[112:115], v[32:47]
  v_mfma_f32_32x32x16_bf16 v[48:63], v[132:135], v[112:115], v[48:63]
  ds_read_b64_tr_b16 v[128:129], v5 offset:25088
  ds_read_b64_tr_b16 v[130:131], v5 offset:26112
  ds_read_b64_tr_b16 v[132:133], v6 offset:25088
  ds_read_b64_tr_b16 v[134:135], v6 offset:26112
  s_waitcnt vmcnt(2) lgkmcnt(4)
  v_mfma_f32_32x32x16_bf16 v[32:47], v[136:139], v[116:119], v[32:47]
  v_mfma_f32_32x32x16_bf16 v[48:63], v[140:143], v[116:119], v[48:63]
  ds_read_b64_tr_b16 v[136:137], v5 offset:27136
  ds_read_b64_tr_b16 v[138:139], v5 offset:28160
  ds_read_b64_tr_b16 v[140:141], v6 offset:27136
  ds_read_b64_tr_b16 v[142:143], v6 offset:28160
  s_waitcnt vmcnt(1) lgkmcnt(4)
  v_mfma_f32_32x32x16_bf16 v[32:47], v[128:131], v[120:123], v[32:47]
  v_mfma_f32_32x32x16_bf16 v[48:63], v[132:135], v[120:123], v[48:63]
  s_waitcnt vmcnt(0) lgkmcnt(0)
  v_mfma_f32_32x32x16_bf16 v[32:47], v[136:139], v[124:127], v[32:47]
  v_mfma_f32_32x32x16_bf16 v[48:63], v[140:143], v[124:127], v[48:63]
  s_barrier
  s_nop 9
  ds_write_b128 v16, v[32:35] offset:0
  ds_write_b128 v16, v[36:39] offset:1024
  ds_write_b128 v16, v[40:43] offset:2048
  ds_write_b128 v16, v[44:47] offset:3072
  ds_write_b128 v16, v[48:51] offset:16384
  ds_write_b128 v16, v[52:55] offset:17408
  ds_write_b128 v16, v[56:59] offset:18432
  ds_write_b128 v16, v[60:63] offset:19456
  s_waitcnt lgkmcnt(0)
  s_barrier
  ds_read_b128 v[64:67], v17 offset:0
  ds_read_b128 v[68:71], v17 offset:1024
  ds_read_b128 v[72:75], v17 offset:4096
  ds_read_b128 v[76:79], v17 offset:5120
  ds_read_b128 v[80:83], v17 offset:8192
  ds_read_b128 v[84:87], v17 offset:9216
  ds_read_b128 v[88:91], v17 offset:12288
  ds_read_b128 v[92:95], v17 offset:13312
  s_waitcnt lgkmcnt(4)
  v_add_f32 v64, v64, v72
  v_add_f32 v65, v65, v73
  v_add_f32 v66, v66, v74
  v_add_f32 v67, v67, v75
  v_add_f32 v68, v68, v76
  v_add_f32 v69, v69, v77
  v_add_f32 v70, v70, v78
  v_add_f32 v71, v71, v79
  s_waitcnt lgkmcnt(0)
  v_add_f32 v80, v80, v88
  v_add_f32 v81, v81, v89
  v_add_f32 v82, v82, v90
  v_add_f32 v83, v83, v91
  v_add_f32 v84, v84, v92
  v_add_f32 v85, v85, v93
  v_add_f32 v86, v86, v94
  v_add_f32 v87, v87, v95
  v_add_f32 v64, v64, v80
  v_add_f32 v65, v65, v81
  v_add_f32 v66, v66, v82
  v_add_f32 v67, v67, v83
  v_add_f32 v68, v68, v84
  v_add_f32 v69, v69, v85
  v_add_f32 v70, v70, v86
  v_add_f32 v71, v71, v87
  v_cvt_pk_bf16_f32 v20, v64, v65
  v_cvt_pk_bf16_f32 v21, v66, v67
  v_cvt_pk_bf16_f32 v22, v68, v69
  v_cvt_pk_bf16_f32 v23, v70, v71
  s_nop 1
  v_permlane32_swap_b32 v20, v22
  v_permlane32_swap_b32 v21, v23
  s_nop 0
  buffer_store_dwordx4 v[20:23], v18, s[48:51], s31 offen
L_end:
  s_endpgm
L_fallback:
  s_mov_b32 s59, 1
  s_and_b32 s30, s6, 1
  s_cmp_eq_u32 s30, 0
  s_cbranch_scc1 L_fbq
  v_mov_b32 v16, v24
  v_mov_b32 v17, v25
  v_mov_b32 v18, v26
  v_mov_b32 v19, v27
  v_mov_b32 v20, v28
  v_mov_b32 v21, v29
  v_mov_b32 v22, v30
  v_mov_b32 v23, v31
L_fbq:
  s_mov_b64 exec, s[62:63]
  v_mov_b32 v22, 0
  v_mov_b32 v23, 0
  s_mov_b64 exec, -1
  v_mov_b32 v13, 0xff800000
  s_lshl_b32 s64, s3, 18
  s_mov_b32 s30, 0
L_fb1:
  buffer_load_dwordx4 v[104:107], v2, s[36:39], s64 offen sc1
  buffer_load_dwordx4 v[108:111], v2, s[36:39], s64 offen offset:1024 sc1
  s_waitcnt vmcnt(0)
  v_mfma_f32_32x32x16_bf16 v[64:79], v[104:107], v[16:19], 0
  v_mfma_f32_32x32x16_bf16 v[64:79], v[108:111], v[20:23], v[64:79]
  s_nop 11
  v_max3_f32 v13, v13, v64, v65
  v_max3_f32 v13, v13, v66, v67
  v_max3_f32 v13, v13, v68, v69
  v_max3_f32 v13, v13, v70, v71
  v_max3_f32 v13, v13, v72, v73
  v_max3_f32 v13, v13, v74, v75
  v_max3_f32 v13, v13, v76, v77
  v_max3_f32 v13, v13, v78, v79
  s_add_u32 s64, s64, 4096
  s_add_u32 s30, s30, 1
  s_cmp_lt_u32 s30, 64
  s_cbranch_scc1 L_fb1
  v_mov_b32 v14, v13
  s_nop 1
  v_permlane32_swap_b32 v13, v14
  s_nop 0
  v_max_f32 v13, v13, v14
  v_sub_f32 v13, 0, v13
  v_cvt_pk_bf16_f32 v14, v13, v13
  v_and_b32 v14, 0xffff0000, v14
  v_sub_f32 v15, v13, v14
  v_cvt_pk_bf16_f32 v12, v15, v15
  v_and_b32 v12, 0xffff0000, v12
  v_sub_f32 v15, v15, v12
  v_mov_b32 v13, 0
  s_mov_b64 exec, s[62:63]
  v_cvt_pk_bf16_f32 v22, v14, v12
  v_cvt_pk_bf16_f32 v23, v15, v13
  s_mov_b64 exec, -1
  v_mov_b32 v32, 0
  v_mov_b32 v33, 0
  v_mov_b32 v34, 0
  v_mov_b32 v35, 0
  v_mov_b32 v36, 0
  v_mov_b32 v37, 0
  v_mov_b32 v38, 0
  v_mov_b32 v39, 0
  v_mov_b32 v40, 0
  v_mov_b32 v41, 0
  v_mov_b32 v42, 0
  v_mov_b32 v43, 0
  v_mov_b32 v44, 0
  v_mov_b32 v45, 0
  v_mov_b32 v46, 0
  v_mov_b32 v47, 0
  s_lshl_b32 s64, s3, 18
  s_mov_b32 s30, 0
L_fb2:
  buffer_load_dwordx4 v[104:107], v2, s[36:39], s64 offen sc1
  buffer_load_dwordx4 v[108:111], v2, s[36:39], s64 offen offset:1024 sc1
  buffer_load_dwordx4 v[120:123], v2, s[36:39], s64 offen offset:2048 sc1
  buffer_load_dwordx4 v[124:127], v2, s[36:39], s64 offen offset:3072 sc1
  s_waitcnt vmcnt(0)
  v_mfma_f32_32x32x16_bf16 v[64:79], v[104:107], v[16:19], 0
  v_mfma_f32_32x32x16_bf16 v[64:79], v[108:111], v[20:23], v[64:79]
  s_nop 11
  v_exp_f32 v64, v64
  v_exp_f32 v65, v65
  v_exp_f32 v66, v66
  v_exp_f32 v67, v67
  v_exp_f32 v68, v68
  v_exp_f32 v69, v69
  v_exp_f32 v70, v70
  v_exp_f32 v71, v71
  v_exp_f32 v72, v72
  v_exp_f32 v73, v73
  v_exp_f32 v74, v74
  v_exp_f32 v75, v75
  v_exp_f32 v76, v76
  v_exp_f32 v77, v77
  v_exp_f32 v78, v78
  v_exp_f32 v79, v79
  s_nop 0
  v_cvt_pk_bf16_f32 v96, v64, v65
  v_cvt_pk_bf16_f32 v97, v66, v67
  v_cvt_pk_bf16_f32 v98, v68, v69
  v_cvt_pk_bf16_f32 v99, v70, v71
  v_cvt_pk_bf16_f32 v100, v72, v73
  v_cvt_pk_bf16_f32 v101, v74, v75
  v_cvt_pk_bf16_f32 v102, v76, v77
  v_cvt_pk_bf16_f32 v103, v78, v79
  s_nop 1
  v_mfma_f32_32x32x16_bf16 v[32:47], v[120:123], v[96:99], v[32:47]
  v_mfma_f32_32x32x16_bf16 v[32:47], v[124:127], v[100:103], v[32:47]
  s_add_u32 s64, s64, 4096
  s_add_u32 s30, s30, 1
  s_cmp_lt_u32 s30, 64
  s_cbranch_scc1 L_fb2
  s_nop 11
  s_branch L_norm
.section .rodata,"a"
.p2align 6
.amdhsa_kernel gated_mix__mha_block__softmax_full_mha__prompt_kernel
  .amdhsa_next_free_vgpr 252
  .amdhsa_next_free_sgpr 100
  .amdhsa_accum_offset 252
  .amdhsa_group_segment_fixed_size 0
  .amdhsa_kernarg_size 80
  .amdhsa_user_sgpr_count 2
  .amdhsa_user_sgpr_kernarg_segment_ptr 1
  .amdhsa_system_sgpr_workgroup_id_x 1
.end_amdhsa_kernel
```
